```python
import torch

def _softmax(x, axis=-1):
    return torch.softmax(x, dim=axis)
def _gelu(x):
    return torch.nn.functional.gelu(x, approximate="tanh")
def _silu(x):
    return torch.nn.functional.silu(x)
def _sigmoid(x):
    return torch.sigmoid(x)
def _layernorm(x, axis=-1, eps=1e-5):
    m = x.mean(dim=axis, keepdim=True)
    v = x.var(dim=axis, keepdim=True, unbiased=False)
    return (x - m) / torch.sqrt(v + eps)
def _scatter_add(tgt, idx, src, axis=0):
    return tgt.clone().index_add_(axis, idx, src)
def _segment_sum(src, seg, n):
    out = torch.zeros((n,) + src.shape[1:], dtype=src.dtype)
    return out.index_add_(0, seg, src)
def _pad(x, pw):
    flat = tuple(v for pair in reversed(pw) for v in pair)
    return torch.nn.functional.pad(x, flat)

kernel_name = 'sequential_preLN__gqa_block_cached__dense_activation_squared_relu__decode'

def setup_inputs():

    _w = (lambda a: (lambda t: t.to(torch.bfloat16) if t.is_floating_point() else t)(torch.as_tensor(a)))
    def _A_setup():
        B, Sq, D = 8, 1, 448
        Hq, Hkv, Sk, Dh = 16, 8, 4096, 256
        assert Hq % Hkv == 0, (Hq, Hkv)
        return {
            "x": _w((lambda *s: torch.randn(*s, dtype=torch.bfloat16) * 0.05)(B, Sq, D)),
            "k_cache": _w((lambda *s: torch.randn(*s, dtype=torch.bfloat16) * 3.2)(B, Hkv, Sk, Dh)),
            "v_cache": _w((lambda *s: torch.randn(*s, dtype=torch.bfloat16) * 0.4)(B, Hkv, Sk, Dh)),
            "wq": _w((lambda *s: torch.randn(*s, dtype=torch.bfloat16) * 3.2)(D, Hq * Dh) * (D ** -0.5)),
            "wo": _w((lambda *s: torch.randn(*s, dtype=torch.bfloat16) * 0.4)(Hq * Dh, D) * ((Hq * Dh) ** -0.5)),
        }
    _A_in = _A_setup()

    def _B_setup():
        B, S, D, F = 8, 1, 448, 1792
        return {
            "x": _w((lambda *s: torch.randn(*s, dtype=torch.bfloat16) * 0.05)(B, S, D)),
            "w1": _w((lambda *s: torch.randn(*s, dtype=torch.bfloat16) * 0.05)(D, F)),
            "b1": _w((lambda *s: torch.randn(*s, dtype=torch.bfloat16) * 0.8)(F)),
            "w2": _w((lambda *s: torch.randn(*s, dtype=torch.bfloat16) * 0.05)(F, D)),
            "b2": _w((lambda *s: torch.randn(*s, dtype=torch.bfloat16) * 3.2)(D)),
        }
    _B_in = _B_setup()

    return {
        "A_x": _A_in["x"],
        "A_k_cache": _A_in["k_cache"],
        "A_v_cache": _A_in["v_cache"],
        "A_wq": _A_in["wq"],
        "A_wo": _A_in["wo"],
        "B_x": _B_in["x"],
        "B_w1": _B_in["w1"],
        "B_b1": _B_in["b1"],
        "B_w2": _B_in["w2"],
        "B_b2": _B_in["b2"],
    }

def reference(A_x, A_k_cache, A_v_cache, A_wq, A_wo, B_x, B_w1, B_b1, B_w2, B_b2):
    def _A_ref(x, k_cache, v_cache, wq, wo):
        B, Sq, D = x.shape
        Hq, Dh = 16, 256
        Hkv = k_cache.shape[1]
        rep = Hq // Hkv
        q = (lambda x, *d: x.permute(*d))((x @ wq).reshape(B, Sq, Hq, Dh), 0, 2, 1, 3)
        k = (lambda x, n, axis: torch.repeat_interleave(x, n, dim=axis))(k_cache, rep, axis=1)
        v = (lambda x, n, axis: torch.repeat_interleave(x, n, dim=axis))(v_cache, rep, axis=1)
        scores = torch.einsum("bhqd,bhkd->bhqk", q, k) * (Dh ** -0.5)
        p = _softmax(scores, axis=-1)
        o = torch.einsum("bhqk,bhkd->bhqd", p, v)
        return (lambda x, *d: x.permute(*d))(o, 0, 2, 1, 3).reshape(B, Sq, Hq * Dh) @ wo

    def _B_ref(x, w1, b1, w2, b2):
        h = torch.einsum("bsd,df->bsf", x, w1) + b1
        zero = torch.zeros_like(h)
        r = torch.where(h > zero, h, zero)
        h = r * r
        out = torch.einsum("bsf,fd->bsd", h, w2) + b2
        return out

    x = A_x
    h = x + _A_ref(_layernorm(x, axis=-1), A_k_cache, A_v_cache, A_wq, A_wo)
    h2 = h + _B_ref(_layernorm(h, axis=-1), B_w1, B_b1, B_w2, B_b2)
    return h2
```

```asm
; @launch grid=(256,1,1) block=(512,1,1) lds=156160
.amdgcn_target "amdgcn-amd-amdhsa--gfx950"
.text
.globl sequential_preLN__gqa_block_cached__dense_activation_squared_relu__decode_kernel
.p2align 8
.type sequential_preLN__gqa_block_cached__dense_activation_squared_relu__decode_kernel,@function
sequential_preLN__gqa_block_cached__dense_activation_squared_relu__decode_kernel:
  s_cmp_ge_u32 s2, 256
  s_cbranch_scc1 L_end
  s_load_dwordx16 s[16:31], s[0:1], 0
  s_load_dwordx8 s[32:39], s[0:1], 64
  s_load_dwordx2 s[40:41], s[0:1], 96
  v_lshrrev_b32 v1, 6, v0
  v_and_b32 v0, 63, v0
  v_readfirstlane_b32 s3, v1
  s_lshr_b32 s10, s2, 3
  s_lshr_b32 s5, s10, 2
  s_and_b32 s6, s10, 3
  s_add_u32 s11, s6, 1
  s_mul_i32 s11, s11, s6
  s_lshr_b32 s11, s11, 1
  s_sub_u32 s4, s2, s11
  s_and_b32 s4, s4, 7
  s_lshl_b32 s8, s4, 2
  s_add_u32 s8, s8, s6
  s_lshl_b32 s7, s5, 5
  s_add_u32 s7, s7, s8
  s_add_u32 s13, s8, 3
  s_lshr_b32 s13, s13, 3
  s_sub_u32 s13, s8, s13
  s_and_b32 s11, s8, 7
  s_cmp_eq_u32 s11, 4
  s_cselect_b32 s13, 99, s13
  s_mov_b32 s14, 0x3db8aa3b
  s_mov_b32 s12, 0
  v_and_b32 v2, 15, v0
  v_lshrrev_b32 v3, 4, v0
  s_cmp_lt_u32 s3, 4
  s_cbranch_scc1 L_helper
  s_sub_u32 s9, s3, 4
  s_cmp_ge_u32 s13, 28
  s_cselect_b32 s12, 2, 0
  s_cmp_eq_u32 s6, 3
  s_cselect_b32 s12, 1, s12
  s_lshl_b32 s10, s5, 3
  s_add_u32 s10, s10, s4
  s_lshl_b32 s10, s10, 21
  s_lshl_b32 s11, s6, 19
  s_add_u32 s10, s10, s11
  s_lshl_b32 s11, s9, 11
  s_add_u32 s15, s10, s11
  v_lshlrev_b32 v1, 9, v3
  v_lshl_add_u32 v1, v2, 4, v1
  s_waitcnt lgkmcnt(0)
  s_mov_b32 s44, s18
  s_mov_b32 s45, s19
  s_mov_b32 s46, 0x8000000
  s_mov_b32 s47, 0x20000
  s_mov_b32 s48, s20
  s_mov_b32 s49, s21
  s_mov_b32 s50, 0x8000000
  s_mov_b32 s51, 0x20000
  s_mov_b32 s22, s15
  s_add_u32 s19, s15, s11
  s_mul_i32 s21, s9, 16384
  s_add_u32 s21, s21, 65536
  s_add_u32 s23, s22, 0
  buffer_load_dwordx4 v[96:99], v1, s[44:47], s23 offen nt
  buffer_load_dwordx4 v[100:103], v1, s[44:47], s23 offen offset:256 nt
  s_add_u32 s23, s22, 8192
  buffer_load_dwordx4 v[104:107], v1, s[44:47], s23 offen nt
  buffer_load_dwordx4 v[108:111], v1, s[44:47], s23 offen offset:256 nt
  s_add_u32 s23, s22, 16384
  buffer_load_dwordx4 v[112:115], v1, s[44:47], s23 offen nt
  buffer_load_dwordx4 v[116:119], v1, s[44:47], s23 offen offset:256 nt
  s_add_u32 s23, s22, 24576
  buffer_load_dwordx4 v[120:123], v1, s[44:47], s23 offen nt
  buffer_load_dwordx4 v[124:127], v1, s[44:47], s23 offen offset:256 nt
  s_barrier
  s_mov_b32 s88, s40
  s_mov_b32 s89, s41
  s_mov_b32 s90, 0x800000
  s_mov_b32 s91, 0x20000
  v_and_b32 v8, 7, v2
  v_and_b32 v11, 1, v8
  v_mov_b32 v12, 0xffff
  v_lshlrev_b32 v11, 4, v11
  v_lshlrev_b32 v12, v11, v12
  v_lshrrev_b32 v11, 1, v8
  v_cmp_eq_u32 vcc, 0, v11
  s_nop 1
  v_cndmask_b32 v4, 0, v12, vcc
  v_cmp_eq_u32 vcc, 1, v11
  s_nop 1
  v_cndmask_b32 v5, 0, v12, vcc
  v_cmp_eq_u32 vcc, 2, v11
  s_nop 1
  v_cndmask_b32 v6, 0, v12, vcc
  v_cmp_eq_u32 vcc, 3, v11
  s_nop 1
  v_cndmask_b32 v7, 0, v12, vcc
  s_mov_b32 s24, 0x01000100
  s_mov_b32 s25, 0x03020302
  s_waitcnt vmcnt(6)
  s_add_u32 s23, s22, 32768
  buffer_load_dwordx4 v[128:131], v1, s[44:47], s23 offen nt
  buffer_load_dwordx4 v[132:135], v1, s[44:47], s23 offen offset:256 nt
  s_waitcnt vmcnt(6)
  s_add_u32 s23, s22, 40960
  buffer_load_dwordx4 v[136:139], v1, s[44:47], s23 offen nt
  buffer_load_dwordx4 v[140:143], v1, s[44:47], s23 offen offset:256 nt
  s_waitcnt vmcnt(6)
  s_add_u32 s23, s22, 49152
  buffer_load_dwordx4 v[144:147], v1, s[44:47], s23 offen nt
  buffer_load_dwordx4 v[148:151], v1, s[44:47], s23 offen offset:256 nt
  s_waitcnt vmcnt(6)
  s_add_u32 s23, s22, 57344
  buffer_load_dwordx4 v[152:155], v1, s[44:47], s23 offen nt
  buffer_load_dwordx4 v[156:159], v1, s[44:47], s23 offen offset:256 nt
  s_waitcnt vmcnt(6)
  s_add_u32 s23, s22, 65536
  buffer_load_dwordx4 v[160:163], v1, s[44:47], s23 offen nt
  buffer_load_dwordx4 v[164:167], v1, s[44:47], s23 offen offset:256 nt
  s_waitcnt vmcnt(6)
  s_add_u32 s23, s22, 73728
  buffer_load_dwordx4 v[168:171], v1, s[44:47], s23 offen nt
  buffer_load_dwordx4 v[172:175], v1, s[44:47], s23 offen offset:256 nt
  s_waitcnt vmcnt(6)
  s_add_u32 s23, s22, 81920
  buffer_load_dwordx4 v[176:179], v1, s[44:47], s23 offen nt
  buffer_load_dwordx4 v[180:183], v1, s[44:47], s23 offen offset:256 nt
  s_waitcnt vmcnt(6)
  s_add_u32 s23, s22, 90112
  buffer_load_dwordx4 v[184:187], v1, s[44:47], s23 offen nt
  buffer_load_dwordx4 v[188:191], v1, s[44:47], s23 offen offset:256 nt
  s_waitcnt vmcnt(6)
  s_add_u32 s23, s22, 98304
  buffer_load_dwordx4 v[192:195], v1, s[44:47], s23 offen nt
  buffer_load_dwordx4 v[196:199], v1, s[44:47], s23 offen offset:256 nt
  s_waitcnt vmcnt(6)
  s_add_u32 s23, s22, 106496
  buffer_load_dwordx4 v[200:203], v1, s[44:47], s23 offen nt
  buffer_load_dwordx4 v[204:207], v1, s[44:47], s23 offen offset:256 nt
  s_waitcnt vmcnt(6)
  s_add_u32 s23, s22, 114688
  buffer_load_dwordx4 v[208:211], v1, s[44:47], s23 offen nt
  buffer_load_dwordx4 v[212:215], v1, s[44:47], s23 offen offset:256 nt
  s_waitcnt vmcnt(6)
  s_add_u32 s23, s22, 122880
  buffer_load_dwordx4 v[216:219], v1, s[44:47], s23 offen nt
  buffer_load_dwordx4 v[220:223], v1, s[44:47], s23 offen offset:256 nt
  s_waitcnt vmcnt(6)
  s_add_u32 s23, s22, 131072
  buffer_load_dwordx4 v[224:227], v1, s[44:47], s23 offen nt
  buffer_load_dwordx4 v[228:231], v1, s[44:47], s23 offen offset:256 nt
  s_waitcnt vmcnt(6)
  s_add_u32 s23, s22, 139264
  buffer_load_dwordx4 v[232:235], v1, s[44:47], s23 offen nt
  buffer_load_dwordx4 v[236:239], v1, s[44:47], s23 offen offset:256 nt
  s_waitcnt vmcnt(6)
  s_add_u32 s23, s22, 147456
  buffer_load_dwordx4 v[240:243], v1, s[44:47], s23 offen nt
  buffer_load_dwordx4 v[244:247], v1, s[44:47], s23 offen offset:256 nt
  s_waitcnt vmcnt(6)
  s_add_u32 s23, s22, 155648
  buffer_load_dwordx4 v[248:251], v1, s[44:47], s23 offen nt
  buffer_load_dwordx4 v[252:255], v1, s[44:47], s23 offen offset:256 nt
  s_waitcnt vmcnt(6)
  s_add_u32 s23, s22, 163840
  s_add_u32 m0, s21, 0
  s_nop 0
  buffer_load_dwordx4 v1, s[44:47], s23 offen nt lds
  s_add_u32 m0, s21, 768
  s_nop 0
  buffer_load_dwordx4 v1, s[44:47], s23 offen offset:256 nt lds
  s_waitcnt vmcnt(6)
  s_add_u32 s23, s22, 172032
  s_add_u32 m0, s21, 2048
  s_nop 0
  buffer_load_dwordx4 v1, s[44:47], s23 offen nt lds
  s_add_u32 m0, s21, 2816
  s_nop 0
  buffer_load_dwordx4 v1, s[44:47], s23 offen offset:256 nt lds
  s_waitcnt vmcnt(6)
  s_add_u32 s23, s22, 180224
  s_add_u32 m0, s21, 4096
  s_nop 0
  buffer_load_dwordx4 v1, s[44:47], s23 offen nt lds
  s_add_u32 m0, s21, 4864
  s_nop 0
  buffer_load_dwordx4 v1, s[44:47], s23 offen offset:256 nt lds
  s_waitcnt vmcnt(6)
  s_add_u32 s23, s22, 188416
  s_add_u32 m0, s21, 6144
  s_nop 0
  buffer_load_dwordx4 v1, s[44:47], s23 offen nt lds
  s_add_u32 m0, s21, 6912
  s_nop 0
  buffer_load_dwordx4 v1, s[44:47], s23 offen offset:256 nt lds
  s_waitcnt vmcnt(6)
  s_add_u32 s23, s22, 196608
  s_add_u32 m0, s21, 8192
  s_nop 0
  buffer_load_dwordx4 v1, s[44:47], s23 offen nt lds
  s_add_u32 m0, s21, 8960
  s_nop 0
  buffer_load_dwordx4 v1, s[44:47], s23 offen offset:256 nt lds
  s_waitcnt vmcnt(6)
  s_add_u32 s23, s22, 204800
  s_add_u32 m0, s21, 10240
  s_nop 0
  buffer_load_dwordx4 v1, s[44:47], s23 offen nt lds
  s_add_u32 m0, s21, 11008
  s_nop 0
  buffer_load_dwordx4 v1, s[44:47], s23 offen offset:256 nt lds
  s_waitcnt vmcnt(6)
  s_add_u32 s23, s22, 212992
  s_add_u32 m0, s21, 12288
  s_nop 0
  buffer_load_dwordx4 v1, s[44:47], s23 offen nt lds
  s_add_u32 m0, s21, 13056
  s_nop 0
  buffer_load_dwordx4 v1, s[44:47], s23 offen offset:256 nt lds
  s_waitcnt vmcnt(6)
  s_add_u32 s23, s22, 221184
  s_add_u32 m0, s21, 14336
  s_nop 0
  buffer_load_dwordx4 v1, s[44:47], s23 offen nt lds
  s_add_u32 m0, s21, 15104
  s_nop 0
  buffer_load_dwordx4 v1, s[44:47], s23 offen offset:256 nt lds
  v_lshlrev_b32 v8, 4, v0
  v_add_u32 v8, s21, v8
  v_mov_b32 v32, 0
  v_mov_b32 v33, 0
  v_mov_b32 v34, 0
  v_mov_b32 v35, 0
  v_mov_b32 v36, 0
  v_mov_b32 v37, 0
  v_mov_b32 v38, 0
  v_mov_b32 v39, 0
  v_mov_b32 v11, 0xff800000
  v_mov_b32 v12, 0
  v_lshrrev_b32 v14, 3, v2
  v_lshlrev_b32 v14, 9, v14
  v_lshl_add_u32 v14, v2, 4, v14
  v_xor_b32 v15, 512, v14
  v_add_u32 v14, 131072, v14
  v_add_u32 v15, 131072, v15
  s_barrier
  ds_read_b128 v[16:19], v14
  ds_read_b128 v[20:23], v14 offset:256
  ds_read_b128 v[24:27], v15
  ds_read_b128 v[28:31], v15 offset:256
  s_waitcnt lgkmcnt(0)
  s_waitcnt vmcnt(52)
  v_dot2_f32_bf16 v48, v96, v16, 0
  v_dot2_f32_bf16 v49, v96, v24, 0
  v_dot2_f32_bf16 v50, v104, v16, 0
  v_dot2_f32_bf16 v51, v104, v24, 0
  v_dot2_f32_bf16 v48, v97, v17, v48
  v_dot2_f32_bf16 v49, v97, v25, v49
  v_dot2_f32_bf16 v50, v105, v17, v50
  v_dot2_f32_bf16 v51, v105, v25, v51
  v_dot2_f32_bf16 v48, v98, v18, v48
  v_dot2_f32_bf16 v49, v98, v26, v49
  v_dot2_f32_bf16 v50, v106, v18, v50
  v_dot2_f32_bf16 v51, v106, v26, v51
  v_dot2_f32_bf16 v48, v99, v19, v48
  v_dot2_f32_bf16 v49, v99, v27, v49
  v_dot2_f32_bf16 v50, v107, v19, v50
  v_dot2_f32_bf16 v51, v107, v27, v51
  v_dot2_f32_bf16 v48, v100, v20, v48
  v_dot2_f32_bf16 v49, v100, v28, v49
  v_dot2_f32_bf16 v50, v108, v20, v50
  v_dot2_f32_bf16 v51, v108, v28, v51
  v_dot2_f32_bf16 v48, v101, v21, v48
  v_dot2_f32_bf16 v49, v101, v29, v49
  v_dot2_f32_bf16 v50, v109, v21, v50
  v_dot2_f32_bf16 v51, v109, v29, v51
  v_dot2_f32_bf16 v48, v102, v22, v48
  v_dot2_f32_bf16 v49, v102, v30, v49
  v_dot2_f32_bf16 v50, v110, v22, v50
  v_dot2_f32_bf16 v51, v110, v30, v51
  v_dot2_f32_bf16 v48, v103, v23, v48
  v_dot2_f32_bf16 v49, v103, v31, v49
  v_dot2_f32_bf16 v50, v111, v23, v50
  v_dot2_f32_bf16 v51, v111, v31, v51
  s_waitcnt vmcnt(6)
  s_cmp_eq_u32 s12, 0
  s_cbranch_scc1 L_pw_1
  s_waitcnt vmcnt(5)
  s_cmp_eq_u32 s12, 1
  s_cbranch_scc1 L_pw_1
  s_waitcnt vmcnt(4)
  L_pw_1:
  s_add_u32 s23, s22, 229376
  buffer_load_dwordx4 v[96:99], v1, s[44:47], s23 offen nt
  buffer_load_dwordx4 v[100:103], v1, s[44:47], s23 offen offset:256 nt
  s_waitcnt vmcnt(6)
  s_cmp_eq_u32 s12, 0
  s_cbranch_scc1 L_pw_2
  s_waitcnt vmcnt(5)
  s_cmp_eq_u32 s12, 1
  s_cbranch_scc1 L_pw_2
  s_waitcnt vmcnt(4)
  L_pw_2:
  s_add_u32 s23, s22, 237568
  buffer_load_dwordx4 v[104:107], v1, s[44:47], s23 offen nt
  buffer_load_dwordx4 v[108:111], v1, s[44:47], s23 offen offset:256 nt
  s_waitcnt vmcnt(16)
  ds_read_b128 v[40:43], v8 offset:0
  ds_read_b128 v[44:47], v8 offset:1024
  ds_read_b128 v[88:91], v8 offset:2048
  ds_read_b128 v[92:95], v8 offset:3072
  v_dot2_f32_bf16 v52, v112, v16, 0
  v_dot2_f32_bf16 v53, v112, v24, 0
  v_dot2_f32_bf16 v54, v120, v16, 0
  v_add_f32_dpp v48, v49, v48 row_ror:8 row_mask:0xf bank_mask:0xf
  v_dot2_f32_bf16 v55, v120, v24, 0
  v_dot2_f32_bf16 v52, v113, v17, v52
  v_dot2_f32_bf16 v53, v113, v25, v53
  v_add_f32_dpp v50, v51, v50 row_ror:8 row_mask:0xf bank_mask:0xf
  v_dot2_f32_bf16 v54, v121, v17, v54
  v_dot2_f32_bf16 v55, v121, v25, v55
  v_dot2_f32_bf16 v52, v114, v18, v52
  v_add_f32_dpp v48, v48, v48 quad_perm:[1,0,3,2] row_mask:0xf bank_mask:0xf
  v_dot2_f32_bf16 v53, v114, v26, v53
  v_dot2_f32_bf16 v54, v122, v18, v54
  v_dot2_f32_bf16 v55, v122, v26, v55
  v_add_f32_dpp v50, v50, v50 quad_perm:[1,0,3,2] row_mask:0xf bank_mask:0xf
  v_dot2_f32_bf16 v52, v115, v19, v52
  v_dot2_f32_bf16 v53, v115, v27, v53
  v_dot2_f32_bf16 v54, v123, v19, v54
  v_add_f32_dpp v48, v48, v48 quad_perm:[2,3,0,1] row_mask:0xf bank_mask:0xf
  v_dot2_f32_bf16 v55, v123, v27, v55
  v_dot2_f32_bf16 v52, v116, v20, v52
  v_dot2_f32_bf16 v53, v116, v28, v53
  v_add_f32_dpp v50, v50, v50 quad_perm:[2,3,0,1] row_mask:0xf bank_mask:0xf
  v_dot2_f32_bf16 v54, v124, v20, v54
  v_dot2_f32_bf16 v55, v124, v28, v55
  v_dot2_f32_bf16 v52, v117, v21, v52
  v_add_f32_dpp v48, v48, v48 row_half_mirror row_mask:0xf bank_mask:0xf
  v_dot2_f32_bf16 v53, v117, v29, v53
  v_dot2_f32_bf16 v54, v125, v21, v54
  v_dot2_f32_bf16 v55, v125, v29, v55
  v_add_f32_dpp v50, v50, v50 row_half_mirror row_mask:0xf bank_mask:0xf
  v_dot2_f32_bf16 v52, v118, v22, v52
  v_dot2_f32_bf16 v53, v118, v30, v53
  v_dot2_f32_bf16 v54, v126, v22, v54
  v_cvt_pk_bf16_f32 v56, v48, v50
  v_dot2_f32_bf16 v55, v126, v30, v55
  v_dot2_f32_bf16 v52, v119, v23, v52
  v_dot2_f32_bf16 v53, v119, v31, v53
  v_max3_f32 v11, v48, v50, v11
  v_dot2_f32_bf16 v54, v127, v23, v54
  v_dot2_f32_bf16 v55, v127, v31, v55
  s_waitcnt vmcnt(6)
  s_cmp_eq_u32 s12, 0
  s_cbranch_scc1 L_pw_3
  s_waitcnt vmcnt(5)
  s_cmp_eq_u32 s12, 1
  s_cbranch_scc1 L_pw_3
  s_waitcnt vmcnt(4)
  L_pw_3:
  s_add_u32 s23, s22, 245760
  buffer_load_dwordx4 v[112:115], v1, s[44:47], s23 offen nt
  buffer_load_dwordx4 v[116:119], v1, s[44:47], s23 offen offset:256 nt
  s_waitcnt vmcnt(6)
  s_cmp_eq_u32 s12, 0
  s_cbranch_scc1 L_pw_4
  s_waitcnt vmcnt(5)
  s_cmp_eq_u32 s12, 1
  s_cbranch_scc1 L_pw_4
  s_waitcnt vmcnt(4)
  L_pw_4:
  s_add_u32 s23, s22, 253952
  buffer_load_dwordx4 v[120:123], v1, s[44:47], s23 offen nt
  buffer_load_dwordx4 v[124:127], v1, s[44:47], s23 offen offset:256 nt
  s_waitcnt lgkmcnt(0)
  v_dot2_f32_bf16 v48, v40, v16, 0
  v_dot2_f32_bf16 v49, v40, v24, 0
  v_dot2_f32_bf16 v50, v88, v16, 0
  v_add_f32_dpp v52, v53, v52 row_ror:8 row_mask:0xf bank_mask:0xf
  v_dot2_f32_bf16 v51, v88, v24, 0
  v_dot2_f32_bf16 v48, v41, v17, v48
  v_dot2_f32_bf16 v49, v41, v25, v49
  v_add_f32_dpp v54, v55, v54 row_ror:8 row_mask:0xf bank_mask:0xf
  v_dot2_f32_bf16 v50, v89, v17, v50
  v_dot2_f32_bf16 v51, v89, v25, v51
  v_dot2_f32_bf16 v48, v42, v18, v48
  v_add_f32_dpp v52, v52, v52 quad_perm:[1,0,3,2] row_mask:0xf bank_mask:0xf
  v_dot2_f32_bf16 v49, v42, v26, v49
  v_dot2_f32_bf16 v50, v90, v18, v50
  v_dot2_f32_bf16 v51, v90, v26, v51
  v_add_f32_dpp v54, v54, v54 quad_perm:[1,0,3,2] row_mask:0xf bank_mask:0xf
  v_dot2_f32_bf16 v48, v43, v19, v48
  v_dot2_f32_bf16 v49, v43, v27, v49
  v_dot2_f32_bf16 v50, v91, v19, v50
  v_add_f32_dpp v52, v52, v52 quad_perm:[2,3,0,1] row_mask:0xf bank_mask:0xf
  v_dot2_f32_bf16 v51, v91, v27, v51
  v_dot2_f32_bf16 v48, v44, v20, v48
  v_dot2_f32_bf16 v49, v44, v28, v49
  v_add_f32_dpp v54, v54, v54 quad_perm:[2,3,0,1] row_mask:0xf bank_mask:0xf
  v_dot2_f32_bf16 v50, v92, v20, v50
  v_dot2_f32_bf16 v51, v92, v28, v51
  v_dot2_f32_bf16 v48, v45, v21, v48
  v_add_f32_dpp v52, v52, v52 row_half_mirror row_mask:0xf bank_mask:0xf
  v_dot2_f32_bf16 v49, v45, v29, v49
  v_dot2_f32_bf16 v50, v93, v21, v50
  v_dot2_f32_bf16 v51, v93, v29, v51
  v_add_f32_dpp v54, v54, v54 row_half_mirror row_mask:0xf bank_mask:0xf
  v_dot2_f32_bf16 v48, v46, v22, v48
  v_dot2_f32_bf16 v49, v46, v30, v49
  v_dot2_f32_bf16 v50, v94, v22, v50
  v_cvt_pk_bf16_f32 v57, v52, v54
  v_dot2_f32_bf16 v51, v94, v30, v51
  v_dot2_f32_bf16 v48, v47, v23, v48
  v_dot2_f32_bf16 v49, v47, v31, v49
  v_max3_f32 v11, v52, v54, v11
  v_dot2_f32_bf16 v50, v95, v23, v50
  v_dot2_f32_bf16 v51, v95, v31, v51
  s_waitcnt vmcnt(16)
  ds_read_b128 v[40:43], v8 offset:4096
  ds_read_b128 v[44:47], v8 offset:5120
  ds_read_b128 v[88:91], v8 offset:6144
  ds_read_b128 v[92:95], v8 offset:7168
  v_dot2_f32_bf16 v52, v128, v16, 0
  v_dot2_f32_bf16 v53, v128, v24, 0
  v_dot2_f32_bf16 v54, v136, v16, 0
  v_add_f32_dpp v48, v49, v48 row_ror:8 row_mask:0xf bank_mask:0xf
  v_dot2_f32_bf16 v55, v136, v24, 0
  v_dot2_f32_bf16 v52, v129, v17, v52
  v_dot2_f32_bf16 v53, v129, v25, v53
  v_add_f32_dpp v50, v51, v50 row_ror:8 row_mask:0xf bank_mask:0xf
  v_dot2_f32_bf16 v54, v137, v17, v54
  v_dot2_f32_bf16 v55, v137, v25, v55
  v_dot2_f32_bf16 v52, v130, v18, v52
  v_add_f32_dpp v48, v48, v48 quad_perm:[1,0,3,2] row_mask:0xf bank_mask:0xf
  v_dot2_f32_bf16 v53, v130, v26, v53
  v_dot2_f32_bf16 v54, v138, v18, v54
  v_dot2_f32_bf16 v55, v138, v26, v55
  v_add_f32_dpp v50, v50, v50 quad_perm:[1,0,3,2] row_mask:0xf bank_mask:0xf
  v_dot2_f32_bf16 v52, v131, v19, v52
  v_dot2_f32_bf16 v53, v131, v27, v53
  v_dot2_f32_bf16 v54, v139, v19, v54
  v_add_f32_dpp v48, v48, v48 quad_perm:[2,3,0,1] row_mask:0xf bank_mask:0xf
  v_dot2_f32_bf16 v55, v139, v27, v55
  v_dot2_f32_bf16 v52, v132, v20, v52
  v_dot2_f32_bf16 v53, v132, v28, v53
  v_add_f32_dpp v50, v50, v50 quad_perm:[2,3,0,1] row_mask:0xf bank_mask:0xf
  v_dot2_f32_bf16 v54, v140, v20, v54
  v_dot2_f32_bf16 v55, v140, v28, v55
  v_dot2_f32_bf16 v52, v133, v21, v52
  v_add_f32_dpp v48, v48, v48 row_half_mirror row_mask:0xf bank_mask:0xf
  v_dot2_f32_bf16 v53, v133, v29, v53
  v_dot2_f32_bf16 v54, v141, v21, v54
  v_dot2_f32_bf16 v55, v141, v29, v55
  v_add_f32_dpp v50, v50, v50 row_half_mirror row_mask:0xf bank_mask:0xf
  v_dot2_f32_bf16 v52, v134, v22, v52
  v_dot2_f32_bf16 v53, v134, v30, v53
  v_dot2_f32_bf16 v54, v142, v22, v54
  v_cvt_pk_bf16_f32 v66, v48, v50
  v_dot2_f32_bf16 v55, v142, v30, v55
  v_dot2_f32_bf16 v52, v135, v23, v52
  v_dot2_f32_bf16 v53, v135, v31, v53
  v_max3_f32 v11, v48, v50, v11
  v_dot2_f32_bf16 v54, v143, v23, v54
  v_dot2_f32_bf16 v55, v143, v31, v55
  s_waitcnt vmcnt(6)
  s_cmp_eq_u32 s12, 0
  s_cbranch_scc1 L_pw_5
  s_waitcnt vmcnt(5)
  s_cmp_eq_u32 s12, 1
  s_cbranch_scc1 L_pw_5
  s_waitcnt vmcnt(4)
  L_pw_5:
  s_add_u32 s23, s22, 262144
  buffer_load_dwordx4 v[128:131], v1, s[44:47], s23 offen nt
  buffer_load_dwordx4 v[132:135], v1, s[44:47], s23 offen offset:256 nt
  s_waitcnt lgkmcnt(0)
  v_dot2_f32_bf16 v48, v40, v16, 0
  v_dot2_f32_bf16 v49, v40, v24, 0
  v_dot2_f32_bf16 v50, v88, v16, 0
  v_add_f32_dpp v52, v53, v52 row_ror:8 row_mask:0xf bank_mask:0xf
  v_dot2_f32_bf16 v51, v88, v24, 0
  v_dot2_f32_bf16 v48, v41, v17, v48
  v_dot2_f32_bf16 v49, v41, v25, v49
  v_add_f32_dpp v54, v55, v54 row_ror:8 row_mask:0xf bank_mask:0xf
  v_dot2_f32_bf16 v50, v89, v17, v50
  v_dot2_f32_bf16 v51, v89, v25, v51
  v_dot2_f32_bf16 v48, v42, v18, v48
  v_add_f32_dpp v52, v52, v52 quad_perm:[1,0,3,2] row_mask:0xf bank_mask:0xf
  v_dot2_f32_bf16 v49, v42, v26, v49
  v_dot2_f32_bf16 v50, v90, v18, v50
  v_dot2_f32_bf16 v51, v90, v26, v51
  v_add_f32_dpp v54, v54, v54 quad_perm:[1,0,3,2] row_mask:0xf bank_mask:0xf
  v_dot2_f32_bf16 v48, v43, v19, v48
  v_dot2_f32_bf16 v49, v43, v27, v49
  v_dot2_f32_bf16 v50, v91, v19, v50
  v_add_f32_dpp v52, v52, v52 quad_perm:[2,3,0,1] row_mask:0xf bank_mask:0xf
  v_dot2_f32_bf16 v51, v91, v27, v51
  v_dot2_f32_bf16 v48, v44, v20, v48
  v_dot2_f32_bf16 v49, v44, v28, v49
  v_add_f32_dpp v54, v54, v54 quad_perm:[2,3,0,1] row_mask:0xf bank_mask:0xf
  v_dot2_f32_bf16 v50, v92, v20, v50
  v_dot2_f32_bf16 v51, v92, v28, v51
  v_dot2_f32_bf16 v48, v45, v21, v48
  v_add_f32_dpp v52, v52, v52 row_half_mirror row_mask:0xf bank_mask:0xf
  v_dot2_f32_bf16 v49, v45, v29, v49
  v_dot2_f32_bf16 v50, v93, v21, v50
  v_dot2_f32_bf16 v51, v93, v29, v51
  v_add_f32_dpp v54, v54, v54 row_half_mirror row_mask:0xf bank_mask:0xf
  v_dot2_f32_bf16 v48, v46, v22, v48
  v_dot2_f32_bf16 v49, v46, v30, v49
  v_dot2_f32_bf16 v50, v94, v22, v50
  v_cvt_pk_bf16_f32 v58, v52, v54
  v_dot2_f32_bf16 v51, v94, v30, v51
  v_dot2_f32_bf16 v48, v47, v23, v48
  v_dot2_f32_bf16 v49, v47, v31, v49
  v_max3_f32 v11, v52, v54, v11
  v_dot2_f32_bf16 v50, v95, v23, v50
  v_dot2_f32_bf16 v51, v95, v31, v51
  s_waitcnt vmcnt(6)
  s_cmp_eq_u32 s12, 0
  s_cbranch_scc1 L_pw_6
  s_waitcnt vmcnt(5)
  s_cmp_eq_u32 s12, 1
  s_cbranch_scc1 L_pw_6
  s_waitcnt vmcnt(4)
  L_pw_6:
  s_add_u32 s23, s22, 270336
  buffer_load_dwordx4 v[136:139], v1, s[44:47], s23 offen nt
  buffer_load_dwordx4 v[140:143], v1, s[44:47], s23 offen offset:256 nt
  s_waitcnt vmcnt(16)
  ds_read_b128 v[40:43], v8 offset:8192
  ds_read_b128 v[44:47], v8 offset:9216
  ds_read_b128 v[88:91], v8 offset:10240
  ds_read_b128 v[92:95], v8 offset:11264
  v_dot2_f32_bf16 v52, v144, v16, 0
  v_dot2_f32_bf16 v53, v144, v24, 0
  v_dot2_f32_bf16 v54, v152, v16, 0
  v_add_f32_dpp v48, v49, v48 row_ror:8 row_mask:0xf bank_mask:0xf
  v_dot2_f32_bf16 v55, v152, v24, 0
  v_dot2_f32_bf16 v52, v145, v17, v52
  v_dot2_f32_bf16 v53, v145, v25, v53
  v_add_f32_dpp v50, v51, v50 row_ror:8 row_mask:0xf bank_mask:0xf
  v_dot2_f32_bf16 v54, v153, v17, v54
  v_dot2_f32_bf16 v55, v153, v25, v55
  v_dot2_f32_bf16 v52, v146, v18, v52
  v_add_f32_dpp v48, v48, v48 quad_perm:[1,0,3,2] row_mask:0xf bank_mask:0xf
  v_dot2_f32_bf16 v53, v146, v26, v53
  v_dot2_f32_bf16 v54, v154, v18, v54
  v_dot2_f32_bf16 v55, v154, v26, v55
  v_add_f32_dpp v50, v50, v50 quad_perm:[1,0,3,2] row_mask:0xf bank_mask:0xf
  v_dot2_f32_bf16 v52, v147, v19, v52
  v_dot2_f32_bf16 v53, v147, v27, v53
  v_dot2_f32_bf16 v54, v155, v19, v54
  v_add_f32_dpp v48, v48, v48 quad_perm:[2,3,0,1] row_mask:0xf bank_mask:0xf
  v_dot2_f32_bf16 v55, v155, v27, v55
  v_dot2_f32_bf16 v52, v148, v20, v52
  v_dot2_f32_bf16 v53, v148, v28, v53
  v_add_f32_dpp v50, v50, v50 quad_perm:[2,3,0,1] row_mask:0xf bank_mask:0xf
  v_dot2_f32_bf16 v54, v156, v20, v54
  v_dot2_f32_bf16 v55, v156, v28, v55
  v_dot2_f32_bf16 v52, v149, v21, v52
  v_add_f32_dpp v48, v48, v48 row_half_mirror row_mask:0xf bank_mask:0xf
  v_dot2_f32_bf16 v53, v149, v29, v53
  v_dot2_f32_bf16 v54, v157, v21, v54
  v_dot2_f32_bf16 v55, v157, v29, v55
  v_add_f32_dpp v50, v50, v50 row_half_mirror row_mask:0xf bank_mask:0xf
  v_dot2_f32_bf16 v52, v150, v22, v52
  v_dot2_f32_bf16 v53, v150, v30, v53
  v_dot2_f32_bf16 v54, v158, v22, v54
  v_cvt_pk_bf16_f32 v67, v48, v50
  v_dot2_f32_bf16 v55, v158, v30, v55
  v_dot2_f32_bf16 v52, v151, v23, v52
  v_dot2_f32_bf16 v53, v151, v31, v53
  v_max3_f32 v11, v48, v50, v11
  v_dot2_f32_bf16 v54, v159, v23, v54
  v_dot2_f32_bf16 v55, v159, v31, v55
  s_waitcnt vmcnt(6)
  s_cmp_eq_u32 s12, 0
  s_cbranch_scc1 L_pw_7
  s_waitcnt vmcnt(5)
  s_cmp_eq_u32 s12, 1
  s_cbranch_scc1 L_pw_7
  s_waitcnt vmcnt(4)
  L_pw_7:
  s_add_u32 s23, s22, 278528
  buffer_load_dwordx4 v[144:147], v1, s[44:47], s23 offen nt
  buffer_load_dwordx4 v[148:151], v1, s[44:47], s23 offen offset:256 nt
  s_waitcnt lgkmcnt(0)
  v_dot2_f32_bf16 v48, v40, v16, 0
  v_dot2_f32_bf16 v49, v40, v24, 0
  v_dot2_f32_bf16 v50, v88, v16, 0
  v_add_f32_dpp v52, v53, v52 row_ror:8 row_mask:0xf bank_mask:0xf
  v_dot2_f32_bf16 v51, v88, v24, 0
  v_dot2_f32_bf16 v48, v41, v17, v48
  v_dot2_f32_bf16 v49, v41, v25, v49
  v_add_f32_dpp v54, v55, v54 row_ror:8 row_mask:0xf bank_mask:0xf
  v_dot2_f32_bf16 v50, v89, v17, v50
  v_dot2_f32_bf16 v51, v89, v25, v51
  v_dot2_f32_bf16 v48, v42, v18, v48
  v_add_f32_dpp v52, v52, v52 quad_perm:[1,0,3,2] row_mask:0xf bank_mask:0xf
  v_dot2_f32_bf16 v49, v42, v26, v49
  v_dot2_f32_bf16 v50, v90, v18, v50
  v_dot2_f32_bf16 v51, v90, v26, v51
  v_add_f32_dpp v54, v54, v54 quad_perm:[1,0,3,2] row_mask:0xf bank_mask:0xf
  v_dot2_f32_bf16 v48, v43, v19, v48
  v_dot2_f32_bf16 v49, v43, v27, v49
  v_dot2_f32_bf16 v50, v91, v19, v50
  v_add_f32_dpp v52, v52, v52 quad_perm:[2,3,0,1] row_mask:0xf bank_mask:0xf
  v_dot2_f32_bf16 v51, v91, v27, v51
  v_dot2_f32_bf16 v48, v44, v20, v48
  v_dot2_f32_bf16 v49, v44, v28, v49
  v_add_f32_dpp v54, v54, v54 quad_perm:[2,3,0,1] row_mask:0xf bank_mask:0xf
  v_dot2_f32_bf16 v50, v92, v20, v50
  v_dot2_f32_bf16 v51, v92, v28, v51
  v_dot2_f32_bf16 v48, v45, v21, v48
  v_add_f32_dpp v52, v52, v52 row_half_mirror row_mask:0xf bank_mask:0xf
  v_dot2_f32_bf16 v49, v45, v29, v49
  v_dot2_f32_bf16 v50, v93, v21, v50
  v_dot2_f32_bf16 v51, v93, v29, v51
  v_add_f32_dpp v54, v54, v54 row_half_mirror row_mask:0xf bank_mask:0xf
  v_dot2_f32_bf16 v48, v46, v22, v48
  v_dot2_f32_bf16 v49, v46, v30, v49
  v_dot2_f32_bf16 v50, v94, v22, v50
  v_cvt_pk_bf16_f32 v59, v52, v54
  v_dot2_f32_bf16 v51, v94, v30, v51
  v_dot2_f32_bf16 v48, v47, v23, v48
  v_dot2_f32_bf16 v49, v47, v31, v49
  v_max3_f32 v11, v52, v54, v11
  v_dot2_f32_bf16 v50, v95, v23, v50
  v_dot2_f32_bf16 v51, v95, v31, v51
  s_waitcnt vmcnt(6)
  s_cmp_eq_u32 s12, 0
  s_cbranch_scc1 L_pw_8
  s_waitcnt vmcnt(5)
  s_cmp_eq_u32 s12, 1
  s_cbranch_scc1 L_pw_8
  s_waitcnt vmcnt(4)
  L_pw_8:
  s_add_u32 s23, s22, 286720
  buffer_load_dwordx4 v[152:155], v1, s[44:47], s23 offen nt
  buffer_load_dwordx4 v[156:159], v1, s[44:47], s23 offen offset:256 nt
  s_waitcnt vmcnt(16)
  ds_read_b128 v[40:43], v8 offset:12288
  ds_read_b128 v[44:47], v8 offset:13312
  ds_read_b128 v[88:91], v8 offset:14336
  ds_read_b128 v[92:95], v8 offset:15360
  v_dot2_f32_bf16 v52, v160, v16, 0
  v_dot2_f32_bf16 v53, v160, v24, 0
  v_dot2_f32_bf16 v54, v168, v16, 0
  v_add_f32_dpp v48, v49, v48 row_ror:8 row_mask:0xf bank_mask:0xf
  v_dot2_f32_bf16 v55, v168, v24, 0
  v_dot2_f32_bf16 v52, v161, v17, v52
  v_dot2_f32_bf16 v53, v161, v25, v53
  v_add_f32_dpp v50, v51, v50 row_ror:8 row_mask:0xf bank_mask:0xf
  v_dot2_f32_bf16 v54, v169, v17, v54
  v_dot2_f32_bf16 v55, v169, v25, v55
  v_dot2_f32_bf16 v52, v162, v18, v52
  v_add_f32_dpp v48, v48, v48 quad_perm:[1,0,3,2] row_mask:0xf bank_mask:0xf
  v_dot2_f32_bf16 v53, v162, v26, v53
  v_dot2_f32_bf16 v54, v170, v18, v54
  v_dot2_f32_bf16 v55, v170, v26, v55
  v_add_f32_dpp v50, v50, v50 quad_perm:[1,0,3,2] row_mask:0xf bank_mask:0xf
  v_dot2_f32_bf16 v52, v163, v19, v52
  v_dot2_f32_bf16 v53, v163, v27, v53
  v_dot2_f32_bf16 v54, v171, v19, v54
  v_add_f32_dpp v48, v48, v48 quad_perm:[2,3,0,1] row_mask:0xf bank_mask:0xf
  v_dot2_f32_bf16 v55, v171, v27, v55
  v_dot2_f32_bf16 v52, v164, v20, v52
  v_dot2_f32_bf16 v53, v164, v28, v53
  v_add_f32_dpp v50, v50, v50 quad_perm:[2,3,0,1] row_mask:0xf bank_mask:0xf
  v_dot2_f32_bf16 v54, v172, v20, v54
  v_dot2_f32_bf16 v55, v172, v28, v55
  v_dot2_f32_bf16 v52, v165, v21, v52
  v_add_f32_dpp v48, v48, v48 row_half_mirror row_mask:0xf bank_mask:0xf
  v_dot2_f32_bf16 v53, v165, v29, v53
  v_dot2_f32_bf16 v54, v173, v21, v54
  v_dot2_f32_bf16 v55, v173, v29, v55
  v_add_f32_dpp v50, v50, v50 row_half_mirror row_mask:0xf bank_mask:0xf
  v_dot2_f32_bf16 v52, v166, v22, v52
  v_dot2_f32_bf16 v53, v166, v30, v53
  v_dot2_f32_bf16 v54, v174, v22, v54
  v_cvt_pk_bf16_f32 v68, v48, v50
  v_dot2_f32_bf16 v55, v174, v30, v55
  v_dot2_f32_bf16 v52, v167, v23, v52
  v_dot2_f32_bf16 v53, v167, v31, v53
  v_max3_f32 v11, v48, v50, v11
  v_dot2_f32_bf16 v54, v175, v23, v54
  v_dot2_f32_bf16 v55, v175, v31, v55
  s_waitcnt vmcnt(6)
  s_cmp_eq_u32 s12, 0
  s_cbranch_scc1 L_pw_9
  s_waitcnt vmcnt(5)
  s_cmp_eq_u32 s12, 1
  s_cbranch_scc1 L_pw_9
  s_waitcnt vmcnt(4)
  L_pw_9:
  s_add_u32 s23, s22, 294912
  buffer_load_dwordx4 v[160:163], v1, s[44:47], s23 offen nt
  buffer_load_dwordx4 v[164:167], v1, s[44:47], s23 offen offset:256 nt
  s_waitcnt lgkmcnt(0)
  v_dot2_f32_bf16 v48, v40, v16, 0
  v_dot2_f32_bf16 v49, v40, v24, 0
  v_dot2_f32_bf16 v50, v88, v16, 0
  v_add_f32_dpp v52, v53, v52 row_ror:8 row_mask:0xf bank_mask:0xf
  v_dot2_f32_bf16 v51, v88, v24, 0
  v_dot2_f32_bf16 v48, v41, v17, v48
  v_dot2_f32_bf16 v49, v41, v25, v49
  v_add_f32_dpp v54, v55, v54 row_ror:8 row_mask:0xf bank_mask:0xf
  v_dot2_f32_bf16 v50, v89, v17, v50
  v_dot2_f32_bf16 v51, v89, v25, v51
  v_dot2_f32_bf16 v48, v42, v18, v48
  v_add_f32_dpp v52, v52, v52 quad_perm:[1,0,3,2] row_mask:0xf bank_mask:0xf
  v_dot2_f32_bf16 v49, v42, v26, v49
  v_dot2_f32_bf16 v50, v90, v18, v50
  v_dot2_f32_bf16 v51, v90, v26, v51
  v_add_f32_dpp v54, v54, v54 quad_perm:[1,0,3,2] row_mask:0xf bank_mask:0xf
  v_dot2_f32_bf16 v48, v43, v19, v48
  v_dot2_f32_bf16 v49, v43, v27, v49
  v_dot2_f32_bf16 v50, v91, v19, v50
  v_add_f32_dpp v52, v52, v52 quad_perm:[2,3,0,1] row_mask:0xf bank_mask:0xf
  v_dot2_f32_bf16 v51, v91, v27, v51
  v_dot2_f32_bf16 v48, v44, v20, v48
  v_dot2_f32_bf16 v49, v44, v28, v49
  v_add_f32_dpp v54, v54, v54 quad_perm:[2,3,0,1] row_mask:0xf bank_mask:0xf
  v_dot2_f32_bf16 v50, v92, v20, v50
  v_dot2_f32_bf16 v51, v92, v28, v51
  v_dot2_f32_bf16 v48, v45, v21, v48
  v_add_f32_dpp v52, v52, v52 row_half_mirror row_mask:0xf bank_mask:0xf
  v_dot2_f32_bf16 v49, v45, v29, v49
  v_dot2_f32_bf16 v50, v93, v21, v50
  v_dot2_f32_bf16 v51, v93, v29, v51
  v_add_f32_dpp v54, v54, v54 row_half_mirror row_mask:0xf bank_mask:0xf
  v_dot2_f32_bf16 v48, v46, v22, v48
  v_dot2_f32_bf16 v49, v46, v30, v49
  v_dot2_f32_bf16 v50, v94, v22, v50
  v_cvt_pk_bf16_f32 v60, v52, v54
  v_dot2_f32_bf16 v51, v94, v30, v51
  v_dot2_f32_bf16 v48, v47, v23, v48
  v_dot2_f32_bf16 v49, v47, v31, v49
  v_max3_f32 v11, v52, v54, v11
  v_dot2_f32_bf16 v50, v95, v23, v50
  v_dot2_f32_bf16 v51, v95, v31, v51
  s_waitcnt vmcnt(6)
  s_cmp_eq_u32 s12, 0
  s_cbranch_scc1 L_pw_10
  s_waitcnt vmcnt(5)
  s_cmp_eq_u32 s12, 1
  s_cbranch_scc1 L_pw_10
  s_waitcnt vmcnt(4)
  L_pw_10:
  s_add_u32 s23, s22, 303104
  buffer_load_dwordx4 v[168:171], v1, s[44:47], s23 offen nt
  buffer_load_dwordx4 v[172:175], v1, s[44:47], s23 offen offset:256 nt
  v_mov_b32 v8, 140436
  v_mov_b32 v9, 1
  s_mov_b64 exec, 1
  ds_add_u32 v8, v9
  s_mov_b64 exec, -1
  s_waitcnt vmcnt(52)
  v_dot2_f32_bf16 v52, v176, v16, 0
  v_dot2_f32_bf16 v53, v176, v24, 0
  v_dot2_f32_bf16 v54, v184, v16, 0
  v_add_f32_dpp v48, v49, v48 row_ror:8 row_mask:0xf bank_mask:0xf
  v_dot2_f32_bf16 v55, v184, v24, 0
  v_dot2_f32_bf16 v52, v177, v17, v52
  v_dot2_f32_bf16 v53, v177, v25, v53
  v_add_f32_dpp v50, v51, v50 row_ror:8 row_mask:0xf bank_mask:0xf
  v_dot2_f32_bf16 v54, v185, v17, v54
  v_dot2_f32_bf16 v55, v185, v25, v55
  v_dot2_f32_bf16 v52, v178, v18, v52
  v_add_f32_dpp v48, v48, v48 quad_perm:[1,0,3,2] row_mask:0xf bank_mask:0xf
  v_dot2_f32_bf16 v53, v178, v26, v53
  v_dot2_f32_bf16 v54, v186, v18, v54
  v_dot2_f32_bf16 v55, v186, v26, v55
  v_add_f32_dpp v50, v50, v50 quad_perm:[1,0,3,2] row_mask:0xf bank_mask:0xf
  v_dot2_f32_bf16 v52, v179, v19, v52
  v_dot2_f32_bf16 v53, v179, v27, v53
  v_dot2_f32_bf16 v54, v187, v19, v54
  v_add_f32_dpp v48, v48, v48 quad_perm:[2,3,0,1] row_mask:0xf bank_mask:0xf
  v_dot2_f32_bf16 v55, v187, v27, v55
  v_dot2_f32_bf16 v52, v180, v20, v52
  v_dot2_f32_bf16 v53, v180, v28, v53
  v_add_f32_dpp v50, v50, v50 quad_perm:[2,3,0,1] row_mask:0xf bank_mask:0xf
  v_dot2_f32_bf16 v54, v188, v20, v54
  v_dot2_f32_bf16 v55, v188, v28, v55
  v_dot2_f32_bf16 v52, v181, v21, v52
  v_add_f32_dpp v48, v48, v48 row_half_mirror row_mask:0xf bank_mask:0xf
  v_dot2_f32_bf16 v53, v181, v29, v53
  v_dot2_f32_bf16 v54, v189, v21, v54
  v_dot2_f32_bf16 v55, v189, v29, v55
  v_add_f32_dpp v50, v50, v50 row_half_mirror row_mask:0xf bank_mask:0xf
  v_dot2_f32_bf16 v52, v182, v22, v52
  v_dot2_f32_bf16 v53, v182, v30, v53
  v_dot2_f32_bf16 v54, v190, v22, v54
  v_cvt_pk_bf16_f32 v69, v48, v50
  v_dot2_f32_bf16 v55, v190, v30, v55
  v_dot2_f32_bf16 v52, v183, v23, v52
  v_dot2_f32_bf16 v53, v183, v31, v53
  v_max3_f32 v11, v48, v50, v11
  v_dot2_f32_bf16 v54, v191, v23, v54
  v_dot2_f32_bf16 v55, v191, v31, v55
  s_waitcnt vmcnt(6)
  s_cmp_eq_u32 s12, 0
  s_cbranch_scc1 L_pw_11
  s_waitcnt vmcnt(5)
  s_cmp_eq_u32 s12, 1
  s_cbranch_scc1 L_pw_11
  s_waitcnt vmcnt(4)
  L_pw_11:
  s_add_u32 s23, s22, 311296
  buffer_load_dwordx4 v[176:179], v1, s[44:47], s23 offen nt
  buffer_load_dwordx4 v[180:183], v1, s[44:47], s23 offen offset:256 nt
  s_waitcnt vmcnt(50)
  v_dot2_f32_bf16 v48, v192, v16, 0
  v_dot2_f32_bf16 v49, v192, v24, 0
  v_dot2_f32_bf16 v50, v200, v16, 0
  v_add_f32_dpp v52, v53, v52 row_ror:8 row_mask:0xf bank_mask:0xf
  v_dot2_f32_bf16 v51, v200, v24, 0
  v_dot2_f32_bf16 v48, v193, v17, v48
  v_dot2_f32_bf16 v49, v193, v25, v49
  v_add_f32_dpp v54, v55, v54 row_ror:8 row_mask:0xf bank_mask:0xf
  v_dot2_f32_bf16 v50, v201, v17, v50
  v_dot2_f32_bf16 v51, v201, v25, v51
  v_dot2_f32_bf16 v48, v194, v18, v48
  v_add_f32_dpp v52, v52, v52 quad_perm:[1,0,3,2] row_mask:0xf bank_mask:0xf
  v_dot2_f32_bf16 v49, v194, v26, v49
  v_dot2_f32_bf16 v50, v202, v18, v50
  v_dot2_f32_bf16 v51, v202, v26, v51
  v_add_f32_dpp v54, v54, v54 quad_perm:[1,0,3,2] row_mask:0xf bank_mask:0xf
  v_dot2_f32_bf16 v48, v195, v19, v48
  v_dot2_f32_bf16 v49, v195, v27, v49
  v_dot2_f32_bf16 v50, v203, v19, v50
  v_add_f32_dpp v52, v52, v52 quad_perm:[2,3,0,1] row_mask:0xf bank_mask:0xf
  v_dot2_f32_bf16 v51, v203, v27, v51
  v_dot2_f32_bf16 v48, v196, v20, v48
  v_dot2_f32_bf16 v49, v196, v28, v49
  v_add_f32_dpp v54, v54, v54 quad_perm:[2,3,0,1] row_mask:0xf bank_mask:0xf
  v_dot2_f32_bf16 v50, v204, v20, v50
  v_dot2_f32_bf16 v51, v204, v28, v51
  v_dot2_f32_bf16 v48, v197, v21, v48
  v_add_f32_dpp v52, v52, v52 row_half_mirror row_mask:0xf bank_mask:0xf
  v_dot2_f32_bf16 v49, v197, v29, v49
  v_dot2_f32_bf16 v50, v205, v21, v50
  v_dot2_f32_bf16 v51, v205, v29, v51
  v_add_f32_dpp v54, v54, v54 row_half_mirror row_mask:0xf bank_mask:0xf
  v_dot2_f32_bf16 v48, v198, v22, v48
  v_dot2_f32_bf16 v49, v198, v30, v49
  v_dot2_f32_bf16 v50, v206, v22, v50
  v_cvt_pk_bf16_f32 v61, v52, v54
  v_dot2_f32_bf16 v51, v206, v30, v51
  v_dot2_f32_bf16 v48, v199, v23, v48
  v_dot2_f32_bf16 v49, v199, v31, v49
  v_max3_f32 v11, v52, v54, v11
  v_dot2_f32_bf16 v50, v207, v23, v50
  v_dot2_f32_bf16 v51, v207, v31, v51
  s_waitcnt vmcnt(6)
  s_cmp_eq_u32 s12, 0
  s_cbranch_scc1 L_pw_12
  s_waitcnt vmcnt(5)
  s_cmp_eq_u32 s12, 1
  s_cbranch_scc1 L_pw_12
  s_waitcnt vmcnt(4)
  L_pw_12:
  s_add_u32 s23, s22, 319488
  buffer_load_dwordx4 v[184:187], v1, s[44:47], s23 offen nt
  buffer_load_dwordx4 v[188:191], v1, s[44:47], s23 offen offset:256 nt
  s_waitcnt vmcnt(48)
  v_dot2_f32_bf16 v52, v208, v16, 0
  v_dot2_f32_bf16 v53, v208, v24, 0
  v_dot2_f32_bf16 v54, v216, v16, 0
  v_add_f32_dpp v48, v49, v48 row_ror:8 row_mask:0xf bank_mask:0xf
  v_dot2_f32_bf16 v55, v216, v24, 0
  v_dot2_f32_bf16 v52, v209, v17, v52
  v_dot2_f32_bf16 v53, v209, v25, v53
  v_add_f32_dpp v50, v51, v50 row_ror:8 row_mask:0xf bank_mask:0xf
  v_dot2_f32_bf16 v54, v217, v17, v54
  v_dot2_f32_bf16 v55, v217, v25, v55
  v_dot2_f32_bf16 v52, v210, v18, v52
  v_add_f32_dpp v48, v48, v48 quad_perm:[1,0,3,2] row_mask:0xf bank_mask:0xf
  v_dot2_f32_bf16 v53, v210, v26, v53
  v_dot2_f32_bf16 v54, v218, v18, v54
  v_dot2_f32_bf16 v55, v218, v26, v55
  v_add_f32_dpp v50, v50, v50 quad_perm:[1,0,3,2] row_mask:0xf bank_mask:0xf
  v_dot2_f32_bf16 v52, v211, v19, v52
  v_dot2_f32_bf16 v53, v211, v27, v53
  v_dot2_f32_bf16 v54, v219, v19, v54
  v_add_f32_dpp v48, v48, v48 quad_perm:[2,3,0,1] row_mask:0xf bank_mask:0xf
  v_dot2_f32_bf16 v55, v219, v27, v55
  v_dot2_f32_bf16 v52, v212, v20, v52
  v_dot2_f32_bf16 v53, v212, v28, v53
  v_add_f32_dpp v50, v50, v50 quad_perm:[2,3,0,1] row_mask:0xf bank_mask:0xf
  v_dot2_f32_bf16 v54, v220, v20, v54
  v_dot2_f32_bf16 v55, v220, v28, v55
  v_dot2_f32_bf16 v52, v213, v21, v52
  v_add_f32_dpp v48, v48, v48 row_half_mirror row_mask:0xf bank_mask:0xf
  v_dot2_f32_bf16 v53, v213, v29, v53
  v_dot2_f32_bf16 v54, v221, v21, v54
  v_dot2_f32_bf16 v55, v221, v29, v55
  v_add_f32_dpp v50, v50, v50 row_half_mirror row_mask:0xf bank_mask:0xf
  v_dot2_f32_bf16 v52, v214, v22, v52
  v_dot2_f32_bf16 v53, v214, v30, v53
  v_dot2_f32_bf16 v54, v222, v22, v54
  v_cvt_pk_bf16_f32 v62, v48, v50
  v_dot2_f32_bf16 v55, v222, v30, v55
  v_dot2_f32_bf16 v52, v215, v23, v52
  v_dot2_f32_bf16 v53, v215, v31, v53
  v_max3_f32 v11, v48, v50, v11
  v_dot2_f32_bf16 v54, v223, v23, v54
  v_dot2_f32_bf16 v55, v223, v31, v55
  s_waitcnt vmcnt(6)
  s_cmp_eq_u32 s12, 0
  s_cbranch_scc1 L_pw_13
  s_waitcnt vmcnt(5)
  s_cmp_eq_u32 s12, 1
  s_cbranch_scc1 L_pw_13
  s_waitcnt vmcnt(4)
  L_pw_13:
  s_add_u32 s23, s22, 327680
  buffer_load_dwordx4 v[192:195], v1, s[44:47], s23 offen nt
  buffer_load_dwordx4 v[196:199], v1, s[44:47], s23 offen offset:256 nt
  s_waitcnt vmcnt(46)
  v_dot2_f32_bf16 v48, v224, v16, 0
  v_dot2_f32_bf16 v49, v224, v24, 0
  v_dot2_f32_bf16 v50, v232, v16, 0
  v_add_f32_dpp v52, v53, v52 row_ror:8 row_mask:0xf bank_mask:0xf
  v_dot2_f32_bf16 v51, v232, v24, 0
  v_dot2_f32_bf16 v48, v225, v17, v48
  v_dot2_f32_bf16 v49, v225, v25, v49
  v_add_f32_dpp v54, v55, v54 row_ror:8 row_mask:0xf bank_mask:0xf
  v_dot2_f32_bf16 v50, v233, v17, v50
  v_dot2_f32_bf16 v51, v233, v25, v51
  v_dot2_f32_bf16 v48, v226, v18, v48
  v_add_f32_dpp v52, v52, v52 quad_perm:[1,0,3,2] row_mask:0xf bank_mask:0xf
  v_dot2_f32_bf16 v49, v226, v26, v49
  v_dot2_f32_bf16 v50, v234, v18, v50
  v_dot2_f32_bf16 v51, v234, v26, v51
  v_add_f32_dpp v54, v54, v54 quad_perm:[1,0,3,2] row_mask:0xf bank_mask:0xf
  v_dot2_f32_bf16 v48, v227, v19, v48
  v_dot2_f32_bf16 v49, v227, v27, v49
  v_dot2_f32_bf16 v50, v235, v19, v50
  v_add_f32_dpp v52, v52, v52 quad_perm:[2,3,0,1] row_mask:0xf bank_mask:0xf
  v_dot2_f32_bf16 v51, v235, v27, v51
  v_dot2_f32_bf16 v48, v228, v20, v48
  v_dot2_f32_bf16 v49, v228, v28, v49
  v_add_f32_dpp v54, v54, v54 quad_perm:[2,3,0,1] row_mask:0xf bank_mask:0xf
  v_dot2_f32_bf16 v50, v236, v20, v50
  v_dot2_f32_bf16 v51, v236, v28, v51
  v_dot2_f32_bf16 v48, v229, v21, v48
  v_add_f32_dpp v52, v52, v52 row_half_mirror row_mask:0xf bank_mask:0xf
  v_dot2_f32_bf16 v49, v229, v29, v49
  v_dot2_f32_bf16 v50, v237, v21, v50
  v_dot2_f32_bf16 v51, v237, v29, v51
  v_add_f32_dpp v54, v54, v54 row_half_mirror row_mask:0xf bank_mask:0xf
  v_dot2_f32_bf16 v48, v230, v22, v48
  v_dot2_f32_bf16 v49, v230, v30, v49
  v_dot2_f32_bf16 v50, v238, v22, v50
  v_cvt_pk_bf16_f32 v63, v52, v54
  v_dot2_f32_bf16 v51, v238, v30, v51
  v_dot2_f32_bf16 v48, v231, v23, v48
  v_dot2_f32_bf16 v49, v231, v31, v49
  v_max3_f32 v11, v52, v54, v11
  v_dot2_f32_bf16 v50, v239, v23, v50
  v_dot2_f32_bf16 v51, v239, v31, v51
  s_waitcnt vmcnt(6)
  s_cmp_eq_u32 s12, 0
  s_cbranch_scc1 L_pw_14
  s_waitcnt vmcnt(5)
  s_cmp_eq_u32 s12, 1
  s_cbranch_scc1 L_pw_14
  s_waitcnt vmcnt(4)
  L_pw_14:
  s_add_u32 s23, s22, 335872
  buffer_load_dwordx4 v[200:203], v1, s[44:47], s23 offen nt
  buffer_load_dwordx4 v[204:207], v1, s[44:47], s23 offen offset:256 nt
  s_waitcnt vmcnt(44)
  v_dot2_f32_bf16 v52, v240, v16, 0
  v_dot2_f32_bf16 v53, v240, v24, 0
  v_dot2_f32_bf16 v54, v248, v16, 0
  v_add_f32_dpp v48, v49, v48 row_ror:8 row_mask:0xf bank_mask:0xf
  v_dot2_f32_bf16 v55, v248, v24, 0
  v_dot2_f32_bf16 v52, v241, v17, v52
  v_dot2_f32_bf16 v53, v241, v25, v53
  v_add_f32_dpp v50, v51, v50 row_ror:8 row_mask:0xf bank_mask:0xf
  v_dot2_f32_bf16 v54, v249, v17, v54
  v_dot2_f32_bf16 v55, v249, v25, v55
  v_dot2_f32_bf16 v52, v242, v18, v52
  v_add_f32_dpp v48, v48, v48 quad_perm:[1,0,3,2] row_mask:0xf bank_mask:0xf
  v_dot2_f32_bf16 v53, v242, v26, v53
  v_dot2_f32_bf16 v54, v250, v18, v54
  v_dot2_f32_bf16 v55, v250, v26, v55
  v_add_f32_dpp v50, v50, v50 quad_perm:[1,0,3,2] row_mask:0xf bank_mask:0xf
  v_dot2_f32_bf16 v52, v243, v19, v52
  v_dot2_f32_bf16 v53, v243, v27, v53
  v_dot2_f32_bf16 v54, v251, v19, v54
  v_add_f32_dpp v48, v48, v48 quad_perm:[2,3,0,1] row_mask:0xf bank_mask:0xf
  v_dot2_f32_bf16 v55, v251, v27, v55
  v_dot2_f32_bf16 v52, v244, v20, v52
  v_dot2_f32_bf16 v53, v244, v28, v53
  v_add_f32_dpp v50, v50, v50 quad_perm:[2,3,0,1] row_mask:0xf bank_mask:0xf
  v_dot2_f32_bf16 v54, v252, v20, v54
  v_dot2_f32_bf16 v55, v252, v28, v55
  v_dot2_f32_bf16 v52, v245, v21, v52
  v_add_f32_dpp v48, v48, v48 row_half_mirror row_mask:0xf bank_mask:0xf
  v_dot2_f32_bf16 v53, v245, v29, v53
  v_dot2_f32_bf16 v54, v253, v21, v54
  v_dot2_f32_bf16 v55, v253, v29, v55
  v_add_f32_dpp v50, v50, v50 row_half_mirror row_mask:0xf bank_mask:0xf
  v_dot2_f32_bf16 v52, v246, v22, v52
  v_dot2_f32_bf16 v53, v246, v30, v53
  v_dot2_f32_bf16 v54, v254, v22, v54
  v_cvt_pk_bf16_f32 v64, v48, v50
  v_dot2_f32_bf16 v55, v254, v30, v55
  v_dot2_f32_bf16 v52, v247, v23, v52
  v_dot2_f32_bf16 v53, v247, v31, v53
  v_max3_f32 v11, v48, v50, v11
  v_dot2_f32_bf16 v54, v255, v23, v54
  v_dot2_f32_bf16 v55, v255, v31, v55
  s_waitcnt vmcnt(6)
  s_cmp_eq_u32 s12, 0
  s_cbranch_scc1 L_pw_15
  s_waitcnt vmcnt(5)
  s_cmp_eq_u32 s12, 1
  s_cbranch_scc1 L_pw_15
  s_waitcnt vmcnt(4)
  L_pw_15:
  s_add_u32 s23, s22, 344064
  buffer_load_dwordx4 v[208:211], v1, s[44:47], s23 offen nt
  buffer_load_dwordx4 v[212:215], v1, s[44:47], s23 offen offset:256 nt
  s_waitcnt vmcnt(26)
  v_dot2_f32_bf16 v48, v96, v16, 0
  v_dot2_f32_bf16 v49, v96, v24, 0
  v_dot2_f32_bf16 v50, v104, v16, 0
  v_add_f32_dpp v52, v53, v52 row_ror:8 row_mask:0xf bank_mask:0xf
  v_dot2_f32_bf16 v51, v104, v24, 0
  v_dot2_f32_bf16 v48, v97, v17, v48
  v_dot2_f32_bf16 v49, v97, v25, v49
  v_add_f32_dpp v54, v55, v54 row_ror:8 row_mask:0xf bank_mask:0xf
  v_dot2_f32_bf16 v50, v105, v17, v50
  v_dot2_f32_bf16 v51, v105, v25, v51
  v_dot2_f32_bf16 v48, v98, v18, v48
  v_add_f32_dpp v52, v52, v52 quad_perm:[1,0,3,2] row_mask:0xf bank_mask:0xf
  v_dot2_f32_bf16 v49, v98, v26, v49
  v_dot2_f32_bf16 v50, v106, v18, v50
  v_dot2_f32_bf16 v51, v106, v26, v51
  v_add_f32_dpp v54, v54, v54 quad_perm:[1,0,3,2] row_mask:0xf bank_mask:0xf
  v_dot2_f32_bf16 v48, v99, v19, v48
  v_dot2_f32_bf16 v49, v99, v27, v49
  v_dot2_f32_bf16 v50, v107, v19, v50
  v_add_f32_dpp v52, v52, v52 quad_perm:[2,3,0,1] row_mask:0xf bank_mask:0xf
  v_dot2_f32_bf16 v51, v107, v27, v51
  v_dot2_f32_bf16 v48, v100, v20, v48
  v_dot2_f32_bf16 v49, v100, v28, v49
  v_add_f32_dpp v54, v54, v54 quad_perm:[2,3,0,1] row_mask:0xf bank_mask:0xf
  v_dot2_f32_bf16 v50, v108, v20, v50
  v_dot2_f32_bf16 v51, v108, v28, v51
  v_dot2_f32_bf16 v48, v101, v21, v48
  v_add_f32_dpp v52, v52, v52 row_half_mirror row_mask:0xf bank_mask:0xf
  v_dot2_f32_bf16 v49, v101, v29, v49
  v_dot2_f32_bf16 v50, v109, v21, v50
  v_dot2_f32_bf16 v51, v109, v29, v51
  v_add_f32_dpp v54, v54, v54 row_half_mirror row_mask:0xf bank_mask:0xf
  v_dot2_f32_bf16 v48, v102, v22, v48
  v_dot2_f32_bf16 v49, v102, v30, v49
  v_dot2_f32_bf16 v50, v110, v22, v50
  v_cvt_pk_bf16_f32 v65, v52, v54
  v_dot2_f32_bf16 v51, v110, v30, v51
  v_dot2_f32_bf16 v48, v103, v23, v48
  v_dot2_f32_bf16 v49, v103, v31, v49
  v_max3_f32 v11, v52, v54, v11
  v_dot2_f32_bf16 v50, v111, v23, v50
  v_dot2_f32_bf16 v51, v111, v31, v51
  s_waitcnt vmcnt(6)
  s_cmp_eq_u32 s12, 0
  s_cbranch_scc1 L_pw_16
  s_waitcnt vmcnt(5)
  s_cmp_eq_u32 s12, 1
  s_cbranch_scc1 L_pw_16
  s_waitcnt vmcnt(4)
  L_pw_16:
  s_add_u32 s23, s22, 352256
  buffer_load_dwordx4 v[216:219], v1, s[44:47], s23 offen nt
  buffer_load_dwordx4 v[220:223], v1, s[44:47], s23 offen offset:256 nt
  s_waitcnt vmcnt(24)
  v_dot2_f32_bf16 v52, v112, v16, 0
  v_dot2_f32_bf16 v53, v112, v24, 0
  v_dot2_f32_bf16 v54, v120, v16, 0
  v_add_f32_dpp v48, v49, v48 row_ror:8 row_mask:0xf bank_mask:0xf
  v_dot2_f32_bf16 v55, v120, v24, 0
  v_dot2_f32_bf16 v52, v113, v17, v52
  v_dot2_f32_bf16 v53, v113, v25, v53
  v_add_f32_dpp v50, v51, v50 row_ror:8 row_mask:0xf bank_mask:0xf
  v_dot2_f32_bf16 v54, v121, v17, v54
  v_dot2_f32_bf16 v55, v121, v25, v55
  v_dot2_f32_bf16 v52, v114, v18, v52
  v_add_f32_dpp v48, v48, v48 quad_perm:[1,0,3,2] row_mask:0xf bank_mask:0xf
  v_dot2_f32_bf16 v53, v114, v26, v53
  v_dot2_f32_bf16 v54, v122, v18, v54
  v_dot2_f32_bf16 v55, v122, v26, v55
  v_add_f32_dpp v50, v50, v50 quad_perm:[1,0,3,2] row_mask:0xf bank_mask:0xf
  v_dot2_f32_bf16 v52, v115, v19, v52
  v_dot2_f32_bf16 v53, v115, v27, v53
  v_dot2_f32_bf16 v54, v123, v19, v54
  v_add_f32_dpp v48, v48, v48 quad_perm:[2,3,0,1] row_mask:0xf bank_mask:0xf
  v_dot2_f32_bf16 v55, v123, v27, v55
  v_dot2_f32_bf16 v52, v116, v20, v52
  v_dot2_f32_bf16 v53, v116, v28, v53
  v_add_f32_dpp v50, v50, v50 quad_perm:[2,3,0,1] row_mask:0xf bank_mask:0xf
  v_dot2_f32_bf16 v54, v124, v20, v54
  v_dot2_f32_bf16 v55, v124, v28, v55
  v_dot2_f32_bf16 v52, v117, v21, v52
  v_add_f32_dpp v48, v48, v48 row_half_mirror row_mask:0xf bank_mask:0xf
  v_dot2_f32_bf16 v53, v117, v29, v53
  v_dot2_f32_bf16 v54, v125, v21, v54
  v_dot2_f32_bf16 v55, v125, v29, v55
  v_add_f32_dpp v50, v50, v50 row_half_mirror row_mask:0xf bank_mask:0xf
  v_dot2_f32_bf16 v52, v118, v22, v52
  v_dot2_f32_bf16 v53, v118, v30, v53
  v_dot2_f32_bf16 v54, v126, v22, v54
  v_cvt_pk_bf16_f32 v70, v48, v50
  v_dot2_f32_bf16 v55, v126, v30, v55
  v_dot2_f32_bf16 v52, v119, v23, v52
  v_dot2_f32_bf16 v53, v119, v31, v53
  v_max3_f32 v11, v48, v50, v11
  v_dot2_f32_bf16 v54, v127, v23, v54
  v_dot2_f32_bf16 v55, v127, v31, v55
  s_waitcnt vmcnt(6)
  s_cmp_eq_u32 s12, 0
  s_cbranch_scc1 L_pw_17
  s_waitcnt vmcnt(5)
  s_cmp_eq_u32 s12, 1
  s_cbranch_scc1 L_pw_17
  s_waitcnt vmcnt(4)
  L_pw_17:
  s_add_u32 s23, s22, 360448
  buffer_load_dwordx4 v[224:227], v1, s[44:47], s23 offen nt
  buffer_load_dwordx4 v[228:231], v1, s[44:47], s23 offen offset:256 nt
  s_waitcnt vmcnt(22)
  v_dot2_f32_bf16 v48, v128, v16, 0
  v_dot2_f32_bf16 v49, v128, v24, 0
  v_dot2_f32_bf16 v50, v136, v16, 0
  v_add_f32_dpp v52, v53, v52 row_ror:8 row_mask:0xf bank_mask:0xf
  v_dot2_f32_bf16 v51, v136, v24, 0
  v_dot2_f32_bf16 v48, v129, v17, v48
  v_dot2_f32_bf16 v49, v129, v25, v49
  v_add_f32_dpp v54, v55, v54 row_ror:8 row_mask:0xf bank_mask:0xf
  v_dot2_f32_bf16 v50, v137, v17, v50
  v_dot2_f32_bf16 v51, v137, v25, v51
  v_dot2_f32_bf16 v48, v130, v18, v48
  v_add_f32_dpp v52, v52, v52 quad_perm:[1,0,3,2] row_mask:0xf bank_mask:0xf
  v_dot2_f32_bf16 v49, v130, v26, v49
  v_dot2_f32_bf16 v50, v138, v18, v50
  v_dot2_f32_bf16 v51, v138, v26, v51
  v_add_f32_dpp v54, v54, v54 quad_perm:[1,0,3,2] row_mask:0xf bank_mask:0xf
  v_dot2_f32_bf16 v48, v131, v19, v48
  v_dot2_f32_bf16 v49, v131, v27, v49
  v_dot2_f32_bf16 v50, v139, v19, v50
  v_add_f32_dpp v52, v52, v52 quad_perm:[2,3,0,1] row_mask:0xf bank_mask:0xf
  v_dot2_f32_bf16 v51, v139, v27, v51
  v_dot2_f32_bf16 v48, v132, v20, v48
  v_dot2_f32_bf16 v49, v132, v28, v49
  v_add_f32_dpp v54, v54, v54 quad_perm:[2,3,0,1] row_mask:0xf bank_mask:0xf
  v_dot2_f32_bf16 v50, v140, v20, v50
  v_dot2_f32_bf16 v51, v140, v28, v51
  v_dot2_f32_bf16 v48, v133, v21, v48
  v_add_f32_dpp v52, v52, v52 row_half_mirror row_mask:0xf bank_mask:0xf
  v_dot2_f32_bf16 v49, v133, v29, v49
  v_dot2_f32_bf16 v50, v141, v21, v50
  v_dot2_f32_bf16 v51, v141, v29, v51
  v_add_f32_dpp v54, v54, v54 row_half_mirror row_mask:0xf bank_mask:0xf
  v_dot2_f32_bf16 v48, v134, v22, v48
  v_dot2_f32_bf16 v49, v134, v30, v49
  v_dot2_f32_bf16 v50, v142, v22, v50
  v_cvt_pk_bf16_f32 v71, v52, v54
  v_dot2_f32_bf16 v51, v142, v30, v51
  v_dot2_f32_bf16 v48, v135, v23, v48
  v_dot2_f32_bf16 v49, v135, v31, v49
  v_max3_f32 v11, v52, v54, v11
  v_dot2_f32_bf16 v50, v143, v23, v50
  v_dot2_f32_bf16 v51, v143, v31, v51
  s_waitcnt vmcnt(6)
  s_cmp_eq_u32 s12, 0
  s_cbranch_scc1 L_pw_18
  s_waitcnt vmcnt(5)
  s_cmp_eq_u32 s12, 1
  s_cbranch_scc1 L_pw_18
  s_waitcnt vmcnt(4)
  L_pw_18:
  s_add_u32 s23, s22, 368640
  buffer_load_dwordx4 v[232:235], v1, s[44:47], s23 offen nt
  buffer_load_dwordx4 v[236:239], v1, s[44:47], s23 offen offset:256 nt
  s_waitcnt vmcnt(20)
  v_dot2_f32_bf16 v52, v144, v16, 0
  v_dot2_f32_bf16 v53, v144, v24, 0
  v_dot2_f32_bf16 v54, v152, v16, 0
  v_add_f32_dpp v48, v49, v48 row_ror:8 row_mask:0xf bank_mask:0xf
  v_dot2_f32_bf16 v55, v152, v24, 0
  v_dot2_f32_bf16 v52, v145, v17, v52
  v_dot2_f32_bf16 v53, v145, v25, v53
  v_add_f32_dpp v50, v51, v50 row_ror:8 row_mask:0xf bank_mask:0xf
  v_dot2_f32_bf16 v54, v153, v17, v54
  v_dot2_f32_bf16 v55, v153, v25, v55
  v_dot2_f32_bf16 v52, v146, v18, v52
  v_add_f32_dpp v48, v48, v48 quad_perm:[1,0,3,2] row_mask:0xf bank_mask:0xf
  v_dot2_f32_bf16 v53, v146, v26, v53
  v_dot2_f32_bf16 v54, v154, v18, v54
  v_dot2_f32_bf16 v55, v154, v26, v55
  v_add_f32_dpp v50, v50, v50 quad_perm:[1,0,3,2] row_mask:0xf bank_mask:0xf
  v_dot2_f32_bf16 v52, v147, v19, v52
  v_dot2_f32_bf16 v53, v147, v27, v53
  v_dot2_f32_bf16 v54, v155, v19, v54
  v_add_f32_dpp v48, v48, v48 quad_perm:[2,3,0,1] row_mask:0xf bank_mask:0xf
  v_dot2_f32_bf16 v55, v155, v27, v55
  v_dot2_f32_bf16 v52, v148, v20, v52
  v_dot2_f32_bf16 v53, v148, v28, v53
  v_add_f32_dpp v50, v50, v50 quad_perm:[2,3,0,1] row_mask:0xf bank_mask:0xf
  v_dot2_f32_bf16 v54, v156, v20, v54
  v_dot2_f32_bf16 v55, v156, v28, v55
  v_dot2_f32_bf16 v52, v149, v21, v52
  v_add_f32_dpp v48, v48, v48 row_half_mirror row_mask:0xf bank_mask:0xf
  v_dot2_f32_bf16 v53, v149, v29, v53
  v_dot2_f32_bf16 v54, v157, v21, v54
  v_dot2_f32_bf16 v55, v157, v29, v55
  v_add_f32_dpp v50, v50, v50 row_half_mirror row_mask:0xf bank_mask:0xf
  v_dot2_f32_bf16 v52, v150, v22, v52
  v_dot2_f32_bf16 v53, v150, v30, v53
  v_dot2_f32_bf16 v54, v158, v22, v54
  v_cvt_pk_bf16_f32 v72, v48, v50
  v_dot2_f32_bf16 v55, v158, v30, v55
  v_dot2_f32_bf16 v52, v151, v23, v52
  v_dot2_f32_bf16 v53, v151, v31, v53
  v_max3_f32 v11, v48, v50, v11
  v_dot2_f32_bf16 v54, v159, v23, v54
  v_dot2_f32_bf16 v55, v159, v31, v55
  s_waitcnt vmcnt(6)
  s_cmp_eq_u32 s12, 0
  s_cbranch_scc1 L_pw_19
  s_waitcnt vmcnt(5)
  s_cmp_eq_u32 s12, 1
  s_cbranch_scc1 L_pw_19
  s_waitcnt vmcnt(4)
  L_pw_19:
  s_add_u32 s23, s22, 376832
  buffer_load_dwordx4 v[240:243], v1, s[44:47], s23 offen nt
  buffer_load_dwordx4 v[244:247], v1, s[44:47], s23 offen offset:256 nt
  s_waitcnt vmcnt(18)
  v_dot2_f32_bf16 v48, v160, v16, 0
  v_dot2_f32_bf16 v49, v160, v24, 0
  v_dot2_f32_bf16 v50, v168, v16, 0
  v_add_f32_dpp v52, v53, v52 row_ror:8 row_mask:0xf bank_mask:0xf
  v_dot2_f32_bf16 v51, v168, v24, 0
  v_dot2_f32_bf16 v48, v161, v17, v48
  v_dot2_f32_bf16 v49, v161, v25, v49
  v_add_f32_dpp v54, v55, v54 row_ror:8 row_mask:0xf bank_mask:0xf
  v_dot2_f32_bf16 v50, v169, v17, v50
  v_dot2_f32_bf16 v51, v169, v25, v51
  v_dot2_f32_bf16 v48, v162, v18, v48
  v_add_f32_dpp v52, v52, v52 quad_perm:[1,0,3,2] row_mask:0xf bank_mask:0xf
  v_dot2_f32_bf16 v49, v162, v26, v49
  v_dot2_f32_bf16 v50, v170, v18, v50
  v_dot2_f32_bf16 v51, v170, v26, v51
  v_add_f32_dpp v54, v54, v54 quad_perm:[1,0,3,2] row_mask:0xf bank_mask:0xf
  v_dot2_f32_bf16 v48, v163, v19, v48
  v_dot2_f32_bf16 v49, v163, v27, v49
  v_dot2_f32_bf16 v50, v171, v19, v50
  v_add_f32_dpp v52, v52, v52 quad_perm:[2,3,0,1] row_mask:0xf bank_mask:0xf
  v_dot2_f32_bf16 v51, v171, v27, v51
  v_dot2_f32_bf16 v48, v164, v20, v48
  v_dot2_f32_bf16 v49, v164, v28, v49
  v_add_f32_dpp v54, v54, v54 quad_perm:[2,3,0,1] row_mask:0xf bank_mask:0xf
  v_dot2_f32_bf16 v50, v172, v20, v50
  v_dot2_f32_bf16 v51, v172, v28, v51
  v_dot2_f32_bf16 v48, v165, v21, v48
  v_add_f32_dpp v52, v52, v52 row_half_mirror row_mask:0xf bank_mask:0xf
  v_dot2_f32_bf16 v49, v165, v29, v49
  v_dot2_f32_bf16 v50, v173, v21, v50
  v_dot2_f32_bf16 v51, v173, v29, v51
  v_add_f32_dpp v54, v54, v54 row_half_mirror row_mask:0xf bank_mask:0xf
  v_dot2_f32_bf16 v48, v166, v22, v48
  v_dot2_f32_bf16 v49, v166, v30, v49
  v_dot2_f32_bf16 v50, v174, v22, v50
  v_cvt_pk_bf16_f32 v73, v52, v54
  v_dot2_f32_bf16 v51, v174, v30, v51
  v_dot2_f32_bf16 v48, v167, v23, v48
  v_dot2_f32_bf16 v49, v167, v31, v49
  v_max3_f32 v11, v52, v54, v11
  v_dot2_f32_bf16 v50, v175, v23, v50
  v_dot2_f32_bf16 v51, v175, v31, v51
  s_waitcnt vmcnt(6)
  s_cmp_eq_u32 s12, 0
  s_cbranch_scc1 L_pw_20
  s_waitcnt vmcnt(5)
  s_cmp_eq_u32 s12, 1
  s_cbranch_scc1 L_pw_20
  s_waitcnt vmcnt(4)
  L_pw_20:
  s_add_u32 s23, s22, 385024
  buffer_load_dwordx4 v[248:251], v1, s[44:47], s23 offen nt
  buffer_load_dwordx4 v[252:255], v1, s[44:47], s23 offen offset:256 nt
  s_waitcnt vmcnt(16)
  v_dot2_f32_bf16 v52, v176, v16, 0
  v_dot2_f32_bf16 v53, v176, v24, 0
  v_dot2_f32_bf16 v54, v184, v16, 0
  v_add_f32_dpp v48, v49, v48 row_ror:8 row_mask:0xf bank_mask:0xf
  v_dot2_f32_bf16 v55, v184, v24, 0
  v_dot2_f32_bf16 v52, v177, v17, v52
  v_dot2_f32_bf16 v53, v177, v25, v53
  v_add_f32_dpp v50, v51, v50 row_ror:8 row_mask:0xf bank_mask:0xf
  v_dot2_f32_bf16 v54, v185, v17, v54
  v_dot2_f32_bf16 v55, v185, v25, v55
  v_dot2_f32_bf16 v52, v178, v18, v52
  v_add_f32_dpp v48, v48, v48 quad_perm:[1,0,3,2] row_mask:0xf bank_mask:0xf
  v_dot2_f32_bf16 v53, v178, v26, v53
  v_dot2_f32_bf16 v54, v186, v18, v54
  v_dot2_f32_bf16 v55, v186, v26, v55
  v_add_f32_dpp v50, v50, v50 quad_perm:[1,0,3,2] row_mask:0xf bank_mask:0xf
  v_dot2_f32_bf16 v52, v179, v19, v52
  v_dot2_f32_bf16 v53, v179, v27, v53
  v_dot2_f32_bf16 v54, v187, v19, v54
  v_add_f32_dpp v48, v48, v48 quad_perm:[2,3,0,1] row_mask:0xf bank_mask:0xf
  v_dot2_f32_bf16 v55, v187, v27, v55
  v_dot2_f32_bf16 v52, v180, v20, v52
  v_dot2_f32_bf16 v53, v180, v28, v53
  v_add_f32_dpp v50, v50, v50 quad_perm:[2,3,0,1] row_mask:0xf bank_mask:0xf
  v_dot2_f32_bf16 v54, v188, v20, v54
  v_dot2_f32_bf16 v55, v188, v28, v55
  v_dot2_f32_bf16 v52, v181, v21, v52
  v_add_f32_dpp v48, v48, v48 row_half_mirror row_mask:0xf bank_mask:0xf
  v_dot2_f32_bf16 v53, v181, v29, v53
  v_dot2_f32_bf16 v54, v189, v21, v54
  v_dot2_f32_bf16 v55, v189, v29, v55
  v_add_f32_dpp v50, v50, v50 row_half_mirror row_mask:0xf bank_mask:0xf
  v_dot2_f32_bf16 v52, v182, v22, v52
  v_dot2_f32_bf16 v53, v182, v30, v53
  v_dot2_f32_bf16 v54, v190, v22, v54
  v_cvt_pk_bf16_f32 v74, v48, v50
  v_dot2_f32_bf16 v55, v190, v30, v55
  v_dot2_f32_bf16 v52, v183, v23, v52
  v_dot2_f32_bf16 v53, v183, v31, v53
  v_max3_f32 v11, v48, v50, v11
  v_dot2_f32_bf16 v54, v191, v23, v54
  v_dot2_f32_bf16 v55, v191, v31, v55
  s_waitcnt vmcnt(6)
  s_cmp_eq_u32 s12, 0
  s_cbranch_scc1 L_pw_21
  s_waitcnt vmcnt(5)
  s_cmp_eq_u32 s12, 1
  s_cbranch_scc1 L_pw_21
  s_waitcnt vmcnt(4)
  L_pw_21:
  s_add_u32 s23, s19, 393216
  buffer_load_dwordx4 v[96:99], v1, s[44:47], s23 offen nt
  buffer_load_dwordx4 v[100:103], v1, s[44:47], s23 offen offset:256 nt
  s_waitcnt vmcnt(14)
  v_dot2_f32_bf16 v48, v192, v16, 0
  v_dot2_f32_bf16 v49, v192, v24, 0
  v_dot2_f32_bf16 v50, v200, v16, 0
  v_add_f32_dpp v52, v53, v52 row_ror:8 row_mask:0xf bank_mask:0xf
  v_dot2_f32_bf16 v51, v200, v24, 0
  v_dot2_f32_bf16 v48, v193, v17, v48
  v_dot2_f32_bf16 v49, v193, v25, v49
  v_add_f32_dpp v54, v55, v54 row_ror:8 row_mask:0xf bank_mask:0xf
  v_dot2_f32_bf16 v50, v201, v17, v50
  v_dot2_f32_bf16 v51, v201, v25, v51
  v_dot2_f32_bf16 v48, v194, v18, v48
  v_add_f32_dpp v52, v52, v52 quad_perm:[1,0,3,2] row_mask:0xf bank_mask:0xf
  v_dot2_f32_bf16 v49, v194, v26, v49
  v_dot2_f32_bf16 v50, v202, v18, v50
  v_dot2_f32_bf16 v51, v202, v26, v51
  v_add_f32_dpp v54, v54, v54 quad_perm:[1,0,3,2] row_mask:0xf bank_mask:0xf
  v_dot2_f32_bf16 v48, v195, v19, v48
  v_dot2_f32_bf16 v49, v195, v27, v49
  v_dot2_f32_bf16 v50, v203, v19, v50
  v_add_f32_dpp v52, v52, v52 quad_perm:[2,3,0,1] row_mask:0xf bank_mask:0xf
  v_dot2_f32_bf16 v51, v203, v27, v51
  v_dot2_f32_bf16 v48, v196, v20, v48
  v_dot2_f32_bf16 v49, v196, v28, v49
  v_add_f32_dpp v54, v54, v54 quad_perm:[2,3,0,1] row_mask:0xf bank_mask:0xf
  v_dot2_f32_bf16 v50, v204, v20, v50
  v_dot2_f32_bf16 v51, v204, v28, v51
  v_dot2_f32_bf16 v48, v197, v21, v48
  v_add_f32_dpp v52, v52, v52 row_half_mirror row_mask:0xf bank_mask:0xf
  v_dot2_f32_bf16 v49, v197, v29, v49
  v_dot2_f32_bf16 v50, v205, v21, v50
  v_dot2_f32_bf16 v51, v205, v29, v51
  v_add_f32_dpp v54, v54, v54 row_half_mirror row_mask:0xf bank_mask:0xf
  v_dot2_f32_bf16 v48, v198, v22, v48
  v_dot2_f32_bf16 v49, v198, v30, v49
  v_dot2_f32_bf16 v50, v206, v22, v50
  v_cvt_pk_bf16_f32 v75, v52, v54
  v_dot2_f32_bf16 v51, v206, v30, v51
  v_dot2_f32_bf16 v48, v199, v23, v48
  v_dot2_f32_bf16 v49, v199, v31, v49
  v_max3_f32 v11, v52, v54, v11
  v_dot2_f32_bf16 v50, v207, v23, v50
  v_dot2_f32_bf16 v51, v207, v31, v51
  s_waitcnt vmcnt(6)
  s_cmp_eq_u32 s12, 0
  s_cbranch_scc1 L_pw_22
  s_waitcnt vmcnt(5)
  s_cmp_eq_u32 s12, 1
  s_cbranch_scc1 L_pw_22
  s_waitcnt vmcnt(4)
  L_pw_22:
  s_add_u32 s23, s19, 395264
  buffer_load_dwordx4 v[104:107], v1, s[44:47], s23 offen nt
  buffer_load_dwordx4 v[108:111], v1, s[44:47], s23 offen offset:256 nt
  s_waitcnt vmcnt(12)
  v_dot2_f32_bf16 v52, v208, v16, 0
  v_dot2_f32_bf16 v53, v208, v24, 0
  v_dot2_f32_bf16 v54, v216, v16, 0
  v_add_f32_dpp v48, v49, v48 row_ror:8 row_mask:0xf bank_mask:0xf
  v_dot2_f32_bf16 v55, v216, v24, 0
  v_dot2_f32_bf16 v52, v209, v17, v52
  v_dot2_f32_bf16 v53, v209, v25, v53
  v_add_f32_dpp v50, v51, v50 row_ror:8 row_mask:0xf bank_mask:0xf
  v_dot2_f32_bf16 v54, v217, v17, v54
  v_dot2_f32_bf16 v55, v217, v25, v55
  v_dot2_f32_bf16 v52, v210, v18, v52
  v_add_f32_dpp v48, v48, v48 quad_perm:[1,0,3,2] row_mask:0xf bank_mask:0xf
  v_dot2_f32_bf16 v53, v210, v26, v53
  v_dot2_f32_bf16 v54, v218, v18, v54
  v_dot2_f32_bf16 v55, v218, v26, v55
  v_add_f32_dpp v50, v50, v50 quad_perm:[1,0,3,2] row_mask:0xf bank_mask:0xf
  v_dot2_f32_bf16 v52, v211, v19, v52
  v_dot2_f32_bf16 v53, v211, v27, v53
  v_dot2_f32_bf16 v54, v219, v19, v54
  v_add_f32_dpp v48, v48, v48 quad_perm:[2,3,0,1] row_mask:0xf bank_mask:0xf
  v_dot2_f32_bf16 v55, v219, v27, v55
  v_dot2_f32_bf16 v52, v212, v20, v52
  v_dot2_f32_bf16 v53, v212, v28, v53
  v_add_f32_dpp v50, v50, v50 quad_perm:[2,3,0,1] row_mask:0xf bank_mask:0xf
  v_dot2_f32_bf16 v54, v220, v20, v54
  v_dot2_f32_bf16 v55, v220, v28, v55
  v_dot2_f32_bf16 v52, v213, v21, v52
  v_add_f32_dpp v48, v48, v48 row_half_mirror row_mask:0xf bank_mask:0xf
  v_dot2_f32_bf16 v53, v213, v29, v53
  v_dot2_f32_bf16 v54, v221, v21, v54
  v_dot2_f32_bf16 v55, v221, v29, v55
  v_add_f32_dpp v50, v50, v50 row_half_mirror row_mask:0xf bank_mask:0xf
  v_dot2_f32_bf16 v52, v214, v22, v52
  v_dot2_f32_bf16 v53, v214, v30, v53
  v_dot2_f32_bf16 v54, v222, v22, v54
  v_cvt_pk_bf16_f32 v76, v48, v50
  v_dot2_f32_bf16 v55, v222, v30, v55
  v_dot2_f32_bf16 v52, v215, v23, v52
  v_dot2_f32_bf16 v53, v215, v31, v53
  v_max3_f32 v11, v48, v50, v11
  v_dot2_f32_bf16 v54, v223, v23, v54
  v_dot2_f32_bf16 v55, v223, v31, v55
  s_waitcnt vmcnt(6)
  s_cmp_eq_u32 s12, 0
  s_cbranch_scc1 L_pw_23
  s_waitcnt vmcnt(5)
  s_cmp_eq_u32 s12, 1
  s_cbranch_scc1 L_pw_23
  s_waitcnt vmcnt(4)
  L_pw_23:
  s_add_u32 s23, s19, 409600
  buffer_load_dwordx4 v[112:115], v1, s[44:47], s23 offen nt
  buffer_load_dwordx4 v[116:119], v1, s[44:47], s23 offen offset:256 nt
  s_waitcnt vmcnt(10)
  v_dot2_f32_bf16 v48, v224, v16, 0
  v_dot2_f32_bf16 v49, v224, v24, 0
  v_dot2_f32_bf16 v50, v232, v16, 0
  v_add_f32_dpp v52, v53, v52 row_ror:8 row_mask:0xf bank_mask:0xf
  v_dot2_f32_bf16 v51, v232, v24, 0
  v_dot2_f32_bf16 v48, v225, v17, v48
  v_dot2_f32_bf16 v49, v225, v25, v49
  v_add_f32_dpp v54, v55, v54 row_ror:8 row_mask:0xf bank_mask:0xf
  v_dot2_f32_bf16 v50, v233, v17, v50
  v_dot2_f32_bf16 v51, v233, v25, v51
  v_dot2_f32_bf16 v48, v226, v18, v48
  v_add_f32_dpp v52, v52, v52 quad_perm:[1,0,3,2] row_mask:0xf bank_mask:0xf
  v_dot2_f32_bf16 v49, v226, v26, v49
  v_dot2_f32_bf16 v50, v234, v18, v50
  v_dot2_f32_bf16 v51, v234, v26, v51
  v_add_f32_dpp v54, v54, v54 quad_perm:[1,0,3,2] row_mask:0xf bank_mask:0xf
  v_dot2_f32_bf16 v48, v227, v19, v48
  v_dot2_f32_bf16 v49, v227, v27, v49
  v_dot2_f32_bf16 v50, v235, v19, v50
  v_add_f32_dpp v52, v52, v52 quad_perm:[2,3,0,1] row_mask:0xf bank_mask:0xf
  v_dot2_f32_bf16 v51, v235, v27, v51
  v_dot2_f32_bf16 v48, v228, v20, v48
  v_dot2_f32_bf16 v49, v228, v28, v49
  v_add_f32_dpp v54, v54, v54 quad_perm:[2,3,0,1] row_mask:0xf bank_mask:0xf
  v_dot2_f32_bf16 v50, v236, v20, v50
  v_dot2_f32_bf16 v51, v236, v28, v51
  v_dot2_f32_bf16 v48, v229, v21, v48
  v_add_f32_dpp v52, v52, v52 row_half_mirror row_mask:0xf bank_mask:0xf
  v_dot2_f32_bf16 v49, v229, v29, v49
  v_dot2_f32_bf16 v50, v237, v21, v50
  v_dot2_f32_bf16 v51, v237, v29, v51
  v_add_f32_dpp v54, v54, v54 row_half_mirror row_mask:0xf bank_mask:0xf
  v_dot2_f32_bf16 v48, v230, v22, v48
  v_dot2_f32_bf16 v49, v230, v30, v49
  v_dot2_f32_bf16 v50, v238, v22, v50
  v_cvt_pk_bf16_f32 v77, v52, v54
  v_dot2_f32_bf16 v51, v238, v30, v51
  v_dot2_f32_bf16 v48, v231, v23, v48
  v_dot2_f32_bf16 v49, v231, v31, v49
  v_max3_f32 v11, v52, v54, v11
  v_dot2_f32_bf16 v50, v239, v23, v50
  v_dot2_f32_bf16 v51, v239, v31, v51
  s_waitcnt vmcnt(6)
  s_cmp_eq_u32 s12, 0
  s_cbranch_scc1 L_pw_24
  s_waitcnt vmcnt(5)
  s_cmp_eq_u32 s12, 1
  s_cbranch_scc1 L_pw_24
  s_waitcnt vmcnt(4)
  L_pw_24:
  s_add_u32 s23, s19, 411648
  buffer_load_dwordx4 v[120:123], v1, s[44:47], s23 offen nt
  buffer_load_dwordx4 v[124:127], v1, s[44:47], s23 offen offset:256 nt
  s_waitcnt vmcnt(8)
  v_dot2_f32_bf16 v52, v240, v16, 0
  v_dot2_f32_bf16 v53, v240, v24, 0
  v_dot2_f32_bf16 v54, v248, v16, 0
  v_add_f32_dpp v48, v49, v48 row_ror:8 row_mask:0xf bank_mask:0xf
  v_dot2_f32_bf16 v55, v248, v24, 0
  v_dot2_f32_bf16 v52, v241, v17, v52
  v_dot2_f32_bf16 v53, v241, v25, v53
  v_add_f32_dpp v50, v51, v50 row_ror:8 row_mask:0xf bank_mask:0xf
  v_dot2_f32_bf16 v54, v249, v17, v54
  v_dot2_f32_bf16 v55, v249, v25, v55
  v_dot2_f32_bf16 v52, v242, v18, v52
  v_add_f32_dpp v48, v48, v48 quad_perm:[1,0,3,2] row_mask:0xf bank_mask:0xf
  v_dot2_f32_bf16 v53, v242, v26, v53
  v_dot2_f32_bf16 v54, v250, v18, v54
  v_dot2_f32_bf16 v55, v250, v26, v55
  v_add_f32_dpp v50, v50, v50 quad_perm:[1,0,3,2] row_mask:0xf bank_mask:0xf
  v_dot2_f32_bf16 v52, v243, v19, v52
  v_dot2_f32_bf16 v53, v243, v27, v53
  v_dot2_f32_bf16 v54, v251, v19, v54
  v_add_f32_dpp v48, v48, v48 quad_perm:[2,3,0,1] row_mask:0xf bank_mask:0xf
  v_dot2_f32_bf16 v55, v251, v27, v55
  v_dot2_f32_bf16 v52, v244, v20, v52
  v_dot2_f32_bf16 v53, v244, v28, v53
  v_add_f32_dpp v50, v50, v50 quad_perm:[2,3,0,1] row_mask:0xf bank_mask:0xf
  v_dot2_f32_bf16 v54, v252, v20, v54
  v_dot2_f32_bf16 v55, v252, v28, v55
  v_dot2_f32_bf16 v52, v245, v21, v52
  v_add_f32_dpp v48, v48, v48 row_half_mirror row_mask:0xf bank_mask:0xf
  v_dot2_f32_bf16 v53, v245, v29, v53
  v_dot2_f32_bf16 v54, v253, v21, v54
  v_dot2_f32_bf16 v55, v253, v29, v55
  v_add_f32_dpp v50, v50, v50 row_half_mirror row_mask:0xf bank_mask:0xf
  v_dot2_f32_bf16 v52, v246, v22, v52
  v_dot2_f32_bf16 v53, v246, v30, v53
  v_dot2_f32_bf16 v54, v254, v22, v54
  v_cvt_pk_bf16_f32 v78, v48, v50
  v_dot2_f32_bf16 v55, v254, v30, v55
  v_dot2_f32_bf16 v52, v247, v23, v52
  v_dot2_f32_bf16 v53, v247, v31, v53
  v_max3_f32 v11, v48, v50, v11
  v_dot2_f32_bf16 v54, v255, v23, v54
  v_dot2_f32_bf16 v55, v255, v31, v55
  s_waitcnt vmcnt(6)
  s_cmp_eq_u32 s12, 0
  s_cbranch_scc1 L_pw_25
  s_waitcnt vmcnt(5)
  s_cmp_eq_u32 s12, 1
  s_cbranch_scc1 L_pw_25
  s_waitcnt vmcnt(4)
  L_pw_25:
  s_add_u32 s23, s19, 425984
  buffer_load_dwordx4 v[128:131], v1, s[44:47], s23 offen nt
  buffer_load_dwordx4 v[132:135], v1, s[44:47], s23 offen offset:256 nt
  s_waitcnt vmcnt(6)
  s_cmp_eq_u32 s12, 0
  s_cbranch_scc1 L_pw_26
  s_waitcnt vmcnt(5)
  s_cmp_eq_u32 s12, 1
  s_cbranch_scc1 L_pw_26
  s_waitcnt vmcnt(4)
  L_pw_26:
  s_add_u32 s23, s19, 428032
  buffer_load_dwordx4 v[136:139], v1, s[44:47], s23 offen nt
  buffer_load_dwordx4 v[140:143], v1, s[44:47], s23 offen offset:256 nt
  s_waitcnt vmcnt(8)
  v_dot2_f32_bf16 v48, v96, v16, 0
  v_dot2_f32_bf16 v49, v96, v24, 0
  v_dot2_f32_bf16 v50, v104, v16, 0
  v_add_f32_dpp v52, v53, v52 row_ror:8 row_mask:0xf bank_mask:0xf
  v_dot2_f32_bf16 v51, v104, v24, 0
  v_dot2_f32_bf16 v48, v97, v17, v48
  v_dot2_f32_bf16 v49, v97, v25, v49
  v_add_f32_dpp v54, v55, v54 row_ror:8 row_mask:0xf bank_mask:0xf
  v_dot2_f32_bf16 v50, v105, v17, v50
  v_dot2_f32_bf16 v51, v105, v25, v51
  v_dot2_f32_bf16 v48, v98, v18, v48
  v_add_f32_dpp v52, v52, v52 quad_perm:[1,0,3,2] row_mask:0xf bank_mask:0xf
  v_dot2_f32_bf16 v49, v98, v26, v49
  v_dot2_f32_bf16 v50, v106, v18, v50
  v_dot2_f32_bf16 v51, v106, v26, v51
  v_add_f32_dpp v54, v54, v54 quad_perm:[1,0,3,2] row_mask:0xf bank_mask:0xf
  v_dot2_f32_bf16 v48, v99, v19, v48
  v_dot2_f32_bf16 v49, v99, v27, v49
  v_dot2_f32_bf16 v50, v107, v19, v50
  v_add_f32_dpp v52, v52, v52 quad_perm:[2,3,0,1] row_mask:0xf bank_mask:0xf
  v_dot2_f32_bf16 v51, v107, v27, v51
  v_dot2_f32_bf16 v48, v100, v20, v48
  v_dot2_f32_bf16 v49, v100, v28, v49
  v_add_f32_dpp v54, v54, v54 quad_perm:[2,3,0,1] row_mask:0xf bank_mask:0xf
  v_dot2_f32_bf16 v50, v108, v20, v50
  v_dot2_f32_bf16 v51, v108, v28, v51
  v_dot2_f32_bf16 v48, v101, v21, v48
  v_add_f32_dpp v52, v52, v52 row_half_mirror row_mask:0xf bank_mask:0xf
  v_dot2_f32_bf16 v49, v101, v29, v49
  v_dot2_f32_bf16 v50, v109, v21, v50
  v_dot2_f32_bf16 v51, v109, v29, v51
  v_add_f32_dpp v54, v54, v54 row_half_mirror row_mask:0xf bank_mask:0xf
  v_dot2_f32_bf16 v48, v102, v22, v48
  v_dot2_f32_bf16 v49, v102, v30, v49
  v_dot2_f32_bf16 v50, v110, v22, v50
  v_cvt_pk_bf16_f32 v79, v52, v54
  v_dot2_f32_bf16 v51, v110, v30, v51
  v_dot2_f32_bf16 v48, v103, v23, v48
  v_dot2_f32_bf16 v49, v103, v31, v49
  v_max3_f32 v11, v52, v54, v11
  v_dot2_f32_bf16 v50, v111, v23, v50
  v_dot2_f32_bf16 v51, v111, v31, v51
  s_waitcnt vmcnt(6)
  s_cmp_eq_u32 s12, 0
  s_cbranch_scc1 L_pw_27
  s_waitcnt vmcnt(5)
  s_cmp_eq_u32 s12, 1
  s_cbranch_scc1 L_pw_27
  s_waitcnt vmcnt(4)
  L_pw_27:
  s_add_u32 s23, s19, 442368
  buffer_load_dwordx4 v[144:147], v1, s[44:47], s23 offen nt
  buffer_load_dwordx4 v[148:151], v1, s[44:47], s23 offen offset:256 nt
  s_waitcnt vmcnt(6)
  s_cmp_eq_u32 s12, 0
  s_cbranch_scc1 L_pw_28
  s_waitcnt vmcnt(5)
  s_cmp_eq_u32 s12, 1
  s_cbranch_scc1 L_pw_28
  s_waitcnt vmcnt(4)
  L_pw_28:
  s_add_u32 s23, s19, 444416
  buffer_load_dwordx4 v[152:155], v1, s[44:47], s23 offen nt
  buffer_load_dwordx4 v[156:159], v1, s[44:47], s23 offen offset:256 nt
  s_waitcnt vmcnt(8)
  v_dot2_f32_bf16 v52, v112, v16, 0
  v_dot2_f32_bf16 v53, v112, v24, 0
  v_dot2_f32_bf16 v54, v120, v16, 0
  v_add_f32_dpp v48, v49, v48 row_ror:8 row_mask:0xf bank_mask:0xf
  v_dot2_f32_bf16 v55, v120, v24, 0
  v_dot2_f32_bf16 v52, v113, v17, v52
  v_dot2_f32_bf16 v53, v113, v25, v53
  v_add_f32_dpp v50, v51, v50 row_ror:8 row_mask:0xf bank_mask:0xf
  v_dot2_f32_bf16 v54, v121, v17, v54
  v_dot2_f32_bf16 v55, v121, v25, v55
  v_dot2_f32_bf16 v52, v114, v18, v52
  v_add_f32_dpp v48, v48, v48 quad_perm:[1,0,3,2] row_mask:0xf bank_mask:0xf
  v_dot2_f32_bf16 v53, v114, v26, v53
  v_dot2_f32_bf16 v54, v122, v18, v54
  v_dot2_f32_bf16 v55, v122, v26, v55
  v_add_f32_dpp v50, v50, v50 quad_perm:[1,0,3,2] row_mask:0xf bank_mask:0xf
  v_dot2_f32_bf16 v52, v115, v19, v52
  v_dot2_f32_bf16 v53, v115, v27, v53
  v_dot2_f32_bf16 v54, v123, v19, v54
  v_add_f32_dpp v48, v48, v48 quad_perm:[2,3,0,1] row_mask:0xf bank_mask:0xf
  v_dot2_f32_bf16 v55, v123, v27, v55
  v_dot2_f32_bf16 v52, v116, v20, v52
  v_dot2_f32_bf16 v53, v116, v28, v53
  v_add_f32_dpp v50, v50, v50 quad_perm:[2,3,0,1] row_mask:0xf bank_mask:0xf
  v_dot2_f32_bf16 v54, v124, v20, v54
  v_dot2_f32_bf16 v55, v124, v28, v55
  v_dot2_f32_bf16 v52, v117, v21, v52
  v_add_f32_dpp v48, v48, v48 row_half_mirror row_mask:0xf bank_mask:0xf
  v_dot2_f32_bf16 v53, v117, v29, v53
  v_dot2_f32_bf16 v54, v125, v21, v54
  v_dot2_f32_bf16 v55, v125, v29, v55
  v_add_f32_dpp v50, v50, v50 row_half_mirror row_mask:0xf bank_mask:0xf
  v_dot2_f32_bf16 v52, v118, v22, v52
  v_dot2_f32_bf16 v53, v118, v30, v53
  v_dot2_f32_bf16 v54, v126, v22, v54
  v_cvt_pk_bf16_f32 v80, v48, v50
  v_dot2_f32_bf16 v55, v126, v30, v55
  v_dot2_f32_bf16 v52, v119, v23, v52
  v_dot2_f32_bf16 v53, v119, v31, v53
  v_max3_f32 v11, v48, v50, v11
  v_dot2_f32_bf16 v54, v127, v23, v54
  v_dot2_f32_bf16 v55, v127, v31, v55
  s_waitcnt vmcnt(6)
  s_cmp_eq_u32 s12, 0
  s_cbranch_scc1 L_pw_29
  s_waitcnt vmcnt(5)
  s_cmp_eq_u32 s12, 1
  s_cbranch_scc1 L_pw_29
  s_waitcnt vmcnt(4)
  L_pw_29:
  s_add_u32 s23, s19, 458752
  buffer_load_dwordx4 v[160:163], v1, s[44:47], s23 offen nt
  buffer_load_dwordx4 v[164:167], v1, s[44:47], s23 offen offset:256 nt
  s_waitcnt vmcnt(6)
  s_cmp_eq_u32 s12, 0
  s_cbranch_scc1 L_pw_30
  s_waitcnt vmcnt(5)
  s_cmp_eq_u32 s12, 1
  s_cbranch_scc1 L_pw_30
  s_waitcnt vmcnt(4)
  L_pw_30:
  s_add_u32 s23, s19, 460800
  buffer_load_dwordx4 v[168:171], v1, s[44:47], s23 offen nt
  buffer_load_dwordx4 v[172:175], v1, s[44:47], s23 offen offset:256 nt
  s_waitcnt vmcnt(8)
  v_dot2_f32_bf16 v48, v128, v16, 0
  v_dot2_f32_bf16 v49, v128, v24, 0
  v_dot2_f32_bf16 v50, v136, v16, 0
  v_add_f32_dpp v52, v53, v52 row_ror:8 row_mask:0xf bank_mask:0xf
  v_dot2_f32_bf16 v51, v136, v24, 0
  v_dot2_f32_bf16 v48, v129, v17, v48
  v_dot2_f32_bf16 v49, v129, v25, v49
  v_add_f32_dpp v54, v55, v54 row_ror:8 row_mask:0xf bank_mask:0xf
  v_dot2_f32_bf16 v50, v137, v17, v50
  v_dot2_f32_bf16 v51, v137, v25, v51
  v_dot2_f32_bf16 v48, v130, v18, v48
  v_add_f32_dpp v52, v52, v52 quad_perm:[1,0,3,2] row_mask:0xf bank_mask:0xf
  v_dot2_f32_bf16 v49, v130, v26, v49
  v_dot2_f32_bf16 v50, v138, v18, v50
  v_dot2_f32_bf16 v51, v138, v26, v51
  v_add_f32_dpp v54, v54, v54 quad_perm:[1,0,3,2] row_mask:0xf bank_mask:0xf
  v_dot2_f32_bf16 v48, v131, v19, v48
  v_dot2_f32_bf16 v49, v131, v27, v49
  v_dot2_f32_bf16 v50, v139, v19, v50
  v_add_f32_dpp v52, v52, v52 quad_perm:[2,3,0,1] row_mask:0xf bank_mask:0xf
  v_dot2_f32_bf16 v51, v139, v27, v51
  v_dot2_f32_bf16 v48, v132, v20, v48
  v_dot2_f32_bf16 v49, v132, v28, v49
  v_add_f32_dpp v54, v54, v54 quad_perm:[2,3,0,1] row_mask:0xf bank_mask:0xf
  v_dot2_f32_bf16 v50, v140, v20, v50
  v_dot2_f32_bf16 v51, v140, v28, v51
  v_dot2_f32_bf16 v48, v133, v21, v48
  v_add_f32_dpp v52, v52, v52 row_half_mirror row_mask:0xf bank_mask:0xf
  v_dot2_f32_bf16 v49, v133, v29, v49
  v_dot2_f32_bf16 v50, v141, v21, v50
  v_dot2_f32_bf16 v51, v141, v29, v51
  v_add_f32_dpp v54, v54, v54 row_half_mirror row_mask:0xf bank_mask:0xf
  v_dot2_f32_bf16 v48, v134, v22, v48
  v_dot2_f32_bf16 v49, v134, v30, v49
  v_dot2_f32_bf16 v50, v142, v22, v50
  v_cvt_pk_bf16_f32 v81, v52, v54
  v_dot2_f32_bf16 v51, v142, v30, v51
  v_dot2_f32_bf16 v48, v135, v23, v48
  v_dot2_f32_bf16 v49, v135, v31, v49
  v_max3_f32 v11, v52, v54, v11
  v_dot2_f32_bf16 v50, v143, v23, v50
  v_dot2_f32_bf16 v51, v143, v31, v51
  s_waitcnt vmcnt(6)
  s_cmp_eq_u32 s12, 0
  s_cbranch_scc1 L_pw_31
  s_waitcnt vmcnt(5)
  s_cmp_eq_u32 s12, 1
  s_cbranch_scc1 L_pw_31
  s_waitcnt vmcnt(4)
  L_pw_31:
  s_add_u32 s23, s19, 475136
  buffer_load_dwordx4 v[176:179], v1, s[44:47], s23 offen nt
  buffer_load_dwordx4 v[180:183], v1, s[44:47], s23 offen offset:256 nt
  s_waitcnt vmcnt(6)
  s_cmp_eq_u32 s12, 0
  s_cbranch_scc1 L_pw_32
  s_waitcnt vmcnt(5)
  s_cmp_eq_u32 s12, 1
  s_cbranch_scc1 L_pw_32
  s_waitcnt vmcnt(4)
  L_pw_32:
  s_add_u32 s23, s19, 477184
  buffer_load_dwordx4 v[184:187], v1, s[44:47], s23 offen nt
  buffer_load_dwordx4 v[188:191], v1, s[44:47], s23 offen offset:256 nt
  s_waitcnt vmcnt(8)
  v_dot2_f32_bf16 v52, v144, v16, 0
  v_dot2_f32_bf16 v53, v144, v24, 0
  v_dot2_f32_bf16 v54, v152, v16, 0
  v_add_f32_dpp v48, v49, v48 row_ror:8 row_mask:0xf bank_mask:0xf
  v_dot2_f32_bf16 v55, v152, v24, 0
  v_dot2_f32_bf16 v52, v145, v17, v52
  v_dot2_f32_bf16 v53, v145, v25, v53
  v_add_f32_dpp v50, v51, v50 row_ror:8 row_mask:0xf bank_mask:0xf
  v_dot2_f32_bf16 v54, v153, v17, v54
  v_dot2_f32_bf16 v55, v153, v25, v55
  v_dot2_f32_bf16 v52, v146, v18, v52
  v_add_f32_dpp v48, v48, v48 quad_perm:[1,0,3,2] row_mask:0xf bank_mask:0xf
  v_dot2_f32_bf16 v53, v146, v26, v53
  v_dot2_f32_bf16 v54, v154, v18, v54
  v_dot2_f32_bf16 v55, v154, v26, v55
  v_add_f32_dpp v50, v50, v50 quad_perm:[1,0,3,2] row_mask:0xf bank_mask:0xf
  v_dot2_f32_bf16 v52, v147, v19, v52
  v_dot2_f32_bf16 v53, v147, v27, v53
  v_dot2_f32_bf16 v54, v155, v19, v54
  v_add_f32_dpp v48, v48, v48 quad_perm:[2,3,0,1] row_mask:0xf bank_mask:0xf
  v_dot2_f32_bf16 v55, v155, v27, v55
  v_dot2_f32_bf16 v52, v148, v20, v52
  v_dot2_f32_bf16 v53, v148, v28, v53
  v_add_f32_dpp v50, v50, v50 quad_perm:[2,3,0,1] row_mask:0xf bank_mask:0xf
  v_dot2_f32_bf16 v54, v156, v20, v54
  v_dot2_f32_bf16 v55, v156, v28, v55
  v_dot2_f32_bf16 v52, v149, v21, v52
  v_add_f32_dpp v48, v48, v48 row_half_mirror row_mask:0xf bank_mask:0xf
  v_dot2_f32_bf16 v53, v149, v29, v53
  v_dot2_f32_bf16 v54, v157, v21, v54
  v_dot2_f32_bf16 v55, v157, v29, v55
  v_add_f32_dpp v50, v50, v50 row_half_mirror row_mask:0xf bank_mask:0xf
  v_dot2_f32_bf16 v52, v150, v22, v52
  v_dot2_f32_bf16 v53, v150, v30, v53
  v_dot2_f32_bf16 v54, v158, v22, v54
  v_cvt_pk_bf16_f32 v82, v48, v50
  v_dot2_f32_bf16 v55, v158, v30, v55
  v_dot2_f32_bf16 v52, v151, v23, v52
  v_dot2_f32_bf16 v53, v151, v31, v53
  v_max3_f32 v11, v48, v50, v11
  v_dot2_f32_bf16 v54, v159, v23, v54
  v_dot2_f32_bf16 v55, v159, v31, v55
  s_waitcnt vmcnt(6)
  s_cmp_eq_u32 s12, 0
  s_cbranch_scc1 L_pw_33
  s_waitcnt vmcnt(5)
  s_cmp_eq_u32 s12, 1
  s_cbranch_scc1 L_pw_33
  s_waitcnt vmcnt(4)
  L_pw_33:
  s_add_u32 s23, s19, 491520
  buffer_load_dwordx4 v[192:195], v1, s[44:47], s23 offen nt
  buffer_load_dwordx4 v[196:199], v1, s[44:47], s23 offen offset:256 nt
  s_waitcnt vmcnt(6)
  s_cmp_eq_u32 s12, 0
  s_cbranch_scc1 L_pw_34
  s_waitcnt vmcnt(5)
  s_cmp_eq_u32 s12, 1
  s_cbranch_scc1 L_pw_34
  s_waitcnt vmcnt(4)
  L_pw_34:
  s_add_u32 s23, s19, 493568
  buffer_load_dwordx4 v[200:203], v1, s[44:47], s23 offen nt
  buffer_load_dwordx4 v[204:207], v1, s[44:47], s23 offen offset:256 nt
  s_waitcnt vmcnt(8)
  v_dot2_f32_bf16 v48, v160, v16, 0
  v_dot2_f32_bf16 v49, v160, v24, 0
  v_dot2_f32_bf16 v50, v168, v16, 0
  v_add_f32_dpp v52, v53, v52 row_ror:8 row_mask:0xf bank_mask:0xf
  v_dot2_f32_bf16 v51, v168, v24, 0
  v_dot2_f32_bf16 v48, v161, v17, v48
  v_dot2_f32_bf16 v49, v161, v25, v49
  v_add_f32_dpp v54, v55, v54 row_ror:8 row_mask:0xf bank_mask:0xf
  v_dot2_f32_bf16 v50, v169, v17, v50
  v_dot2_f32_bf16 v51, v169, v25, v51
  v_dot2_f32_bf16 v48, v162, v18, v48
  v_add_f32_dpp v52, v52, v52 quad_perm:[1,0,3,2] row_mask:0xf bank_mask:0xf
  v_dot2_f32_bf16 v49, v162, v26, v49
  v_dot2_f32_bf16 v50, v170, v18, v50
  v_dot2_f32_bf16 v51, v170, v26, v51
  v_add_f32_dpp v54, v54, v54 quad_perm:[1,0,3,2] row_mask:0xf bank_mask:0xf
  v_dot2_f32_bf16 v48, v163, v19, v48
  v_dot2_f32_bf16 v49, v163, v27, v49
  v_dot2_f32_bf16 v50, v171, v19, v50
  v_add_f32_dpp v52, v52, v52 quad_perm:[2,3,0,1] row_mask:0xf bank_mask:0xf
  v_dot2_f32_bf16 v51, v171, v27, v51
  v_dot2_f32_bf16 v48, v164, v20, v48
  v_dot2_f32_bf16 v49, v164, v28, v49
  v_add_f32_dpp v54, v54, v54 quad_perm:[2,3,0,1] row_mask:0xf bank_mask:0xf
  v_dot2_f32_bf16 v50, v172, v20, v50
  v_dot2_f32_bf16 v51, v172, v28, v51
  v_dot2_f32_bf16 v48, v165, v21, v48
  v_add_f32_dpp v52, v52, v52 row_half_mirror row_mask:0xf bank_mask:0xf
  v_dot2_f32_bf16 v49, v165, v29, v49
  v_dot2_f32_bf16 v50, v173, v21, v50
  v_dot2_f32_bf16 v51, v173, v29, v51
  v_add_f32_dpp v54, v54, v54 row_half_mirror row_mask:0xf bank_mask:0xf
  v_dot2_f32_bf16 v48, v166, v22, v48
  v_dot2_f32_bf16 v49, v166, v30, v49
  v_dot2_f32_bf16 v50, v174, v22, v50
  v_cvt_pk_bf16_f32 v83, v52, v54
  v_dot2_f32_bf16 v51, v174, v30, v51
  v_dot2_f32_bf16 v48, v167, v23, v48
  v_dot2_f32_bf16 v49, v167, v31, v49
  v_max3_f32 v11, v52, v54, v11
  v_dot2_f32_bf16 v50, v175, v23, v50
  v_dot2_f32_bf16 v51, v175, v31, v51
  s_waitcnt vmcnt(6)
  s_cmp_eq_u32 s12, 0
  s_cbranch_scc1 L_pw_35
  s_waitcnt vmcnt(5)
  s_cmp_eq_u32 s12, 1
  s_cbranch_scc1 L_pw_35
  s_waitcnt vmcnt(4)
  L_pw_35:
  s_add_u32 s23, s19, 507904
  buffer_load_dwordx4 v[208:211], v1, s[44:47], s23 offen nt
  buffer_load_dwordx4 v[212:215], v1, s[44:47], s23 offen offset:256 nt
  s_waitcnt vmcnt(6)
  s_cmp_eq_u32 s12, 0
  s_cbranch_scc1 L_pw_36
  s_waitcnt vmcnt(5)
  s_cmp_eq_u32 s12, 1
  s_cbranch_scc1 L_pw_36
  s_waitcnt vmcnt(4)
  L_pw_36:
  s_add_u32 s23, s19, 509952
  buffer_load_dwordx4 v[216:219], v1, s[44:47], s23 offen nt
  buffer_load_dwordx4 v[220:223], v1, s[44:47], s23 offen offset:256 nt
  s_waitcnt vmcnt(8)
  v_dot2_f32_bf16 v52, v176, v16, 0
  v_dot2_f32_bf16 v53, v176, v24, 0
  v_dot2_f32_bf16 v54, v184, v16, 0
  v_add_f32_dpp v48, v49, v48 row_ror:8 row_mask:0xf bank_mask:0xf
  v_dot2_f32_bf16 v55, v184, v24, 0
  v_dot2_f32_bf16 v52, v177, v17, v52
  v_dot2_f32_bf16 v53, v177, v25, v53
  v_add_f32_dpp v50, v51, v50 row_ror:8 row_mask:0xf bank_mask:0xf
  v_dot2_f32_bf16 v54, v185, v17, v54
  v_dot2_f32_bf16 v55, v185, v25, v55
  v_dot2_f32_bf16 v52, v178, v18, v52
  v_add_f32_dpp v48, v48, v48 quad_perm:[1,0,3,2] row_mask:0xf bank_mask:0xf
  v_dot2_f32_bf16 v53, v178, v26, v53
  v_dot2_f32_bf16 v54, v186, v18, v54
  v_dot2_f32_bf16 v55, v186, v26, v55
  v_add_f32_dpp v50, v50, v50 quad_perm:[1,0,3,2] row_mask:0xf bank_mask:0xf
  v_dot2_f32_bf16 v52, v179, v19, v52
  v_dot2_f32_bf16 v53, v179, v27, v53
  v_dot2_f32_bf16 v54, v187, v19, v54
  v_add_f32_dpp v48, v48, v48 quad_perm:[2,3,0,1] row_mask:0xf bank_mask:0xf
  v_dot2_f32_bf16 v55, v187, v27, v55
  v_dot2_f32_bf16 v52, v180, v20, v52
  v_dot2_f32_bf16 v53, v180, v28, v53
  v_add_f32_dpp v50, v50, v50 quad_perm:[2,3,0,1] row_mask:0xf bank_mask:0xf
  v_dot2_f32_bf16 v54, v188, v20, v54
  v_dot2_f32_bf16 v55, v188, v28, v55
  v_dot2_f32_bf16 v52, v181, v21, v52
  v_add_f32_dpp v48, v48, v48 row_half_mirror row_mask:0xf bank_mask:0xf
  v_dot2_f32_bf16 v53, v181, v29, v53
  v_dot2_f32_bf16 v54, v189, v21, v54
  v_dot2_f32_bf16 v55, v189, v29, v55
  v_add_f32_dpp v50, v50, v50 row_half_mirror row_mask:0xf bank_mask:0xf
  v_dot2_f32_bf16 v52, v182, v22, v52
  v_dot2_f32_bf16 v53, v182, v30, v53
  v_dot2_f32_bf16 v54, v190, v22, v54
  v_cvt_pk_bf16_f32 v84, v48, v50
  v_dot2_f32_bf16 v55, v190, v30, v55
  v_dot2_f32_bf16 v52, v183, v23, v52
  v_dot2_f32_bf16 v53, v183, v31, v53
  v_max3_f32 v11, v48, v50, v11
  v_dot2_f32_bf16 v54, v191, v23, v54
  v_dot2_f32_bf16 v55, v191, v31, v55
  s_waitcnt vmcnt(6)
  s_cmp_eq_u32 s12, 0
  s_cbranch_scc1 L_pw_37
  s_waitcnt vmcnt(5)
  s_cmp_eq_u32 s12, 1
  s_cbranch_scc1 L_pw_37
  s_waitcnt vmcnt(4)
  L_pw_37:
  s_add_u32 s23, s22, 0
  buffer_load_dwordx4 v[224:227], v1, s[48:51], s23 offen nt
  buffer_load_dwordx4 v[228:231], v1, s[48:51], s23 offen offset:256 nt
  s_waitcnt vmcnt(6)
  s_cmp_eq_u32 s12, 0
  s_cbranch_scc1 L_pw_38
  s_waitcnt vmcnt(5)
  s_cmp_eq_u32 s12, 1
  s_cbranch_scc1 L_pw_38
  s_waitcnt vmcnt(4)
  L_pw_38:
  s_add_u32 s23, s22, 8192
  buffer_load_dwordx4 v[232:235], v1, s[48:51], s23 offen nt
  buffer_load_dwordx4 v[236:239], v1, s[48:51], s23 offen offset:256 nt
  s_waitcnt vmcnt(8)
  v_dot2_f32_bf16 v48, v192, v16, 0
  v_dot2_f32_bf16 v49, v192, v24, 0
  v_dot2_f32_bf16 v50, v200, v16, 0
  v_add_f32_dpp v52, v53, v52 row_ror:8 row_mask:0xf bank_mask:0xf
  v_dot2_f32_bf16 v51, v200, v24, 0
  v_dot2_f32_bf16 v48, v193, v17, v48
  v_dot2_f32_bf16 v49, v193, v25, v49
  v_add_f32_dpp v54, v55, v54 row_ror:8 row_mask:0xf bank_mask:0xf
  v_dot2_f32_bf16 v50, v201, v17, v50
  v_dot2_f32_bf16 v51, v201, v25, v51
  v_dot2_f32_bf16 v48, v194, v18, v48
  v_add_f32_dpp v52, v52, v52 quad_perm:[1,0,3,2] row_mask:0xf bank_mask:0xf
  v_dot2_f32_bf16 v49, v194, v26, v49
  v_dot2_f32_bf16 v50, v202, v18, v50
  v_dot2_f32_bf16 v51, v202, v26, v51
  v_add_f32_dpp v54, v54, v54 quad_perm:[1,0,3,2] row_mask:0xf bank_mask:0xf
  v_dot2_f32_bf16 v48, v195, v19, v48
  v_dot2_f32_bf16 v49, v195, v27, v49
  v_dot2_f32_bf16 v50, v203, v19, v50
  v_add_f32_dpp v52, v52, v52 quad_perm:[2,3,0,1] row_mask:0xf bank_mask:0xf
  v_dot2_f32_bf16 v51, v203, v27, v51
  v_dot2_f32_bf16 v48, v196, v20, v48
  v_dot2_f32_bf16 v49, v196, v28, v49
  v_add_f32_dpp v54, v54, v54 quad_perm:[2,3,0,1] row_mask:0xf bank_mask:0xf
  v_dot2_f32_bf16 v50, v204, v20, v50
  v_dot2_f32_bf16 v51, v204, v28, v51
  v_dot2_f32_bf16 v48, v197, v21, v48
  v_add_f32_dpp v52, v52, v52 row_half_mirror row_mask:0xf bank_mask:0xf
  v_dot2_f32_bf16 v49, v197, v29, v49
  v_dot2_f32_bf16 v50, v205, v21, v50
  v_dot2_f32_bf16 v51, v205, v29, v51
  v_add_f32_dpp v54, v54, v54 row_half_mirror row_mask:0xf bank_mask:0xf
  v_dot2_f32_bf16 v48, v198, v22, v48
  v_dot2_f32_bf16 v49, v198, v30, v49
  v_dot2_f32_bf16 v50, v206, v22, v50
  v_cvt_pk_bf16_f32 v85, v52, v54
  v_dot2_f32_bf16 v51, v206, v30, v51
  v_dot2_f32_bf16 v48, v199, v23, v48
  v_dot2_f32_bf16 v49, v199, v31, v49
  v_max3_f32 v11, v52, v54, v11
  v_dot2_f32_bf16 v50, v207, v23, v50
  v_dot2_f32_bf16 v51, v207, v31, v51
  s_waitcnt vmcnt(6)
  s_cmp_eq_u32 s12, 0
  s_cbranch_scc1 L_pw_39
  s_waitcnt vmcnt(5)
  s_cmp_eq_u32 s12, 1
  s_cbranch_scc1 L_pw_39
  s_waitcnt vmcnt(4)
  L_pw_39:
  s_add_u32 s23, s22, 16384
  buffer_load_dwordx4 v[240:243], v1, s[48:51], s23 offen nt
  buffer_load_dwordx4 v[244:247], v1, s[48:51], s23 offen offset:256 nt
  s_waitcnt vmcnt(6)
  s_cmp_eq_u32 s12, 0
  s_cbranch_scc1 L_pw_40
  s_waitcnt vmcnt(5)
  s_cmp_eq_u32 s12, 1
  s_cbranch_scc1 L_pw_40
  s_waitcnt vmcnt(4)
  L_pw_40:
  s_add_u32 s23, s22, 24576
  buffer_load_dwordx4 v[248:251], v1, s[48:51], s23 offen nt
  buffer_load_dwordx4 v[252:255], v1, s[48:51], s23 offen offset:256 nt
  s_waitcnt vmcnt(8)
  v_dot2_f32_bf16 v52, v208, v16, 0
  v_dot2_f32_bf16 v53, v208, v24, 0
  v_dot2_f32_bf16 v54, v216, v16, 0
  v_add_f32_dpp v48, v49, v48 row_ror:8 row_mask:0xf bank_mask:0xf
  v_dot2_f32_bf16 v55, v216, v24, 0
  v_dot2_f32_bf16 v52, v209, v17, v52
  v_dot2_f32_bf16 v53, v209, v25, v53
  v_add_f32_dpp v50, v51, v50 row_ror:8 row_mask:0xf bank_mask:0xf
  v_dot2_f32_bf16 v54, v217, v17, v54
  v_dot2_f32_bf16 v55, v217, v25, v55
  v_dot2_f32_bf16 v52, v210, v18, v52
  v_add_f32_dpp v48, v48, v48 quad_perm:[1,0,3,2] row_mask:0xf bank_mask:0xf
  v_dot2_f32_bf16 v53, v210, v26, v53
  v_dot2_f32_bf16 v54, v218, v18, v54
  v_dot2_f32_bf16 v55, v218, v26, v55
  v_add_f32_dpp v50, v50, v50 quad_perm:[1,0,3,2] row_mask:0xf bank_mask:0xf
  v_dot2_f32_bf16 v52, v211, v19, v52
  v_dot2_f32_bf16 v53, v211, v27, v53
  v_dot2_f32_bf16 v54, v219, v19, v54
  v_add_f32_dpp v48, v48, v48 quad_perm:[2,3,0,1] row_mask:0xf bank_mask:0xf
  v_dot2_f32_bf16 v55, v219, v27, v55
  v_dot2_f32_bf16 v52, v212, v20, v52
  v_dot2_f32_bf16 v53, v212, v28, v53
  v_add_f32_dpp v50, v50, v50 quad_perm:[2,3,0,1] row_mask:0xf bank_mask:0xf
  v_dot2_f32_bf16 v54, v220, v20, v54
  v_dot2_f32_bf16 v55, v220, v28, v55
  v_dot2_f32_bf16 v52, v213, v21, v52
  v_add_f32_dpp v48, v48, v48 row_half_mirror row_mask:0xf bank_mask:0xf
  v_dot2_f32_bf16 v53, v213, v29, v53
  v_dot2_f32_bf16 v54, v221, v21, v54
  v_dot2_f32_bf16 v55, v221, v29, v55
  v_add_f32_dpp v50, v50, v50 row_half_mirror row_mask:0xf bank_mask:0xf
  v_dot2_f32_bf16 v52, v214, v22, v52
  v_dot2_f32_bf16 v53, v214, v30, v53
  v_dot2_f32_bf16 v54, v222, v22, v54
  v_cvt_pk_bf16_f32 v86, v48, v50
  v_dot2_f32_bf16 v55, v222, v30, v55
  v_dot2_f32_bf16 v52, v215, v23, v52
  v_dot2_f32_bf16 v53, v215, v31, v53
  v_max3_f32 v11, v48, v50, v11
  v_dot2_f32_bf16 v54, v223, v23, v54
  v_dot2_f32_bf16 v55, v223, v31, v55
  s_waitcnt vmcnt(6)
  s_cmp_eq_u32 s12, 0
  s_cbranch_scc1 L_pw_41
  s_waitcnt vmcnt(5)
  s_cmp_eq_u32 s12, 1
  s_cbranch_scc1 L_pw_41
  s_waitcnt vmcnt(4)
  L_pw_41:
  s_add_u32 s23, s22, 32768
  buffer_load_dwordx4 v[96:99], v1, s[48:51], s23 offen nt
  buffer_load_dwordx4 v[100:103], v1, s[48:51], s23 offen offset:256 nt
  s_waitcnt vmcnt(6)
  s_cmp_eq_u32 s12, 0
  s_cbranch_scc1 L_pw_42
  s_waitcnt vmcnt(5)
  s_cmp_eq_u32 s12, 1
  s_cbranch_scc1 L_pw_42
  s_waitcnt vmcnt(4)
  L_pw_42:
  s_add_u32 s23, s22, 40960
  buffer_load_dwordx4 v[104:107], v1, s[48:51], s23 offen nt
  buffer_load_dwordx4 v[108:111], v1, s[48:51], s23 offen offset:256 nt
  s_nop 2
  v_add_f32_dpp v52, v53, v52 row_ror:8 row_mask:0xf bank_mask:0xf
  s_nop 1
  v_add_f32_dpp v54, v55, v54 row_ror:8 row_mask:0xf bank_mask:0xf
  s_nop 1
  v_add_f32_dpp v52, v52, v52 quad_perm:[1,0,3,2] row_mask:0xf bank_mask:0xf
  s_nop 1
  v_add_f32_dpp v54, v54, v54 quad_perm:[1,0,3,2] row_mask:0xf bank_mask:0xf
  s_nop 1
  v_add_f32_dpp v52, v52, v52 quad_perm:[2,3,0,1] row_mask:0xf bank_mask:0xf
  s_nop 1
  v_add_f32_dpp v54, v54, v54 quad_perm:[2,3,0,1] row_mask:0xf bank_mask:0xf
  s_nop 1
  v_add_f32_dpp v52, v52, v52 row_half_mirror row_mask:0xf bank_mask:0xf
  s_nop 1
  v_add_f32_dpp v54, v54, v54 row_half_mirror row_mask:0xf bank_mask:0xf
  s_nop 1
  v_cvt_pk_bf16_f32 v87, v52, v54
  s_nop 1
  v_max3_f32 v11, v52, v54, v11
  s_nop 1
  v_mov_b32 v14, v11
  s_nop 1
  v_permlane16_swap_b32 v11, v14
  s_nop 1
  v_max_f32 v11, v11, v14
  v_mov_b32 v14, v11
  s_nop 1
  v_permlane32_swap_b32 v11, v14
  s_nop 1
  v_max_f32 v11, v11, v14
  v_cvt_pk_bf16_f32 v11, v11, v11
  v_and_b32 v11, 0xffff0000, v11
  v_mul_f32 v13, s14, v11
  v_sub_f32 v13, 0, v13
  v_lshrrev_b32 v16, 3, v2
  v_lshl_add_u32 v16, v3, 1, v16
  v_lshlrev_b32 v17, 6, v16
  v_lshlrev_b32 v16, 2, v16
  s_lshl_b32 s10, s9, 9
  s_add_u32 s10, s10, 146944
  v_add_u32 v17, s10, v17
  ds_write_b128 v17, v[80:83] offset:0
  ds_write_b128 v17, v[84:87] offset:16
  v_mov_b32 v18, 140440
  v_mov_b32 v19, 1
  s_mov_b64 exec, 1
  ds_add_u32 v18, v19
  s_mov_b64 exec, -1
  v_mov_b32 v17, 0
  s_andn2_b32 s10, s7, 3
  s_lshl_b32 s26, s10, 7
  s_add_u32 s26, s26, 589936
  s_lshl_b32 s28, s10, 11
  s_add_u32 s28, s28, 1310720
  s_lshl_b32 s27, s5, 3
  s_add_u32 s27, s27, s4
  s_lshl_b32 s27, s27, 21
  s_add_u32 s27, s27, 393216
  v_lshlrev_b32 v90, 16, v56
  v_and_b32 v91, 0xffff0000, v56
  v_fma_f32 v90, v90, s14, v13
  v_fma_f32 v91, v91, s14, v13
  v_exp_f32 v90, v90
  v_exp_f32 v91, v91
  v_add_f32 v12, v12, v90
  v_cvt_pk_bf16_f32 v56, v90, v91
  v_add_f32 v12, v12, v91
  v_perm_b32 v88, v56, v56, s24
  v_and_b32 v40, v4, v88
  v_and_b32 v41, v5, v88
  v_and_b32 v42, v6, v88
  v_and_b32 v43, v7, v88
  v_lshlrev_b32 v90, 16, v57
  v_and_b32 v91, 0xffff0000, v57
  v_fma_f32 v90, v90, s14, v13
  v_fma_f32 v91, v91, s14, v13
  v_exp_f32 v90, v90
  v_exp_f32 v91, v91
  v_add_f32 v12, v12, v90
  v_cvt_pk_bf16_f32 v57, v90, v91
  v_add_f32 v12, v12, v91
  v_lshlrev_b32 v90, 16, v58
  v_and_b32 v91, 0xffff0000, v58
  v_fma_f32 v90, v90, s14, v13
  v_fma_f32 v91, v91, s14, v13
  v_exp_f32 v90, v90
  v_exp_f32 v91, v91
  v_add_f32 v12, v12, v90
  v_cvt_pk_bf16_f32 v58, v90, v91
  v_add_f32 v12, v12, v91
  v_lshlrev_b32 v90, 16, v59
  v_and_b32 v91, 0xffff0000, v59
  v_fma_f32 v90, v90, s14, v13
  v_fma_f32 v91, v91, s14, v13
  v_exp_f32 v90, v90
  v_exp_f32 v91, v91
  v_add_f32 v12, v12, v90
  v_cvt_pk_bf16_f32 v59, v90, v91
  v_add_f32 v12, v12, v91
  v_lshlrev_b32 v90, 16, v60
  v_and_b32 v91, 0xffff0000, v60
  v_fma_f32 v90, v90, s14, v13
  v_fma_f32 v91, v91, s14, v13
  v_exp_f32 v90, v90
  v_exp_f32 v91, v91
  v_add_f32 v12, v12, v90
  v_cvt_pk_bf16_f32 v60, v90, v91
  v_add_f32 v12, v12, v91
  v_lshlrev_b32 v90, 16, v61
  v_and_b32 v91, 0xffff0000, v61
  v_fma_f32 v90, v90, s14, v13
  v_fma_f32 v91, v91, s14, v13
  v_exp_f32 v90, v90
  v_exp_f32 v91, v91
  v_add_f32 v12, v12, v90
  v_cvt_pk_bf16_f32 v61, v90, v91
  v_add_f32 v12, v12, v91
  v_lshlrev_b32 v90, 16, v62
  v_and_b32 v91, 0xffff0000, v62
  v_fma_f32 v90, v90, s14, v13
  v_fma_f32 v91, v91, s14, v13
  v_exp_f32 v90, v90
  v_exp_f32 v91, v91
  v_add_f32 v12, v12, v90
  v_cvt_pk_bf16_f32 v62, v90, v91
  v_add_f32 v12, v12, v91
  v_lshlrev_b32 v90, 16, v63
  v_and_b32 v91, 0xffff0000, v63
  v_fma_f32 v90, v90, s14, v13
  v_fma_f32 v91, v91, s14, v13
  v_exp_f32 v90, v90
  v_exp_f32 v91, v91
  v_add_f32 v12, v12, v90
  v_cvt_pk_bf16_f32 v63, v90, v91
  v_add_f32 v12, v12, v91
  v_lshlrev_b32 v90, 16, v64
  v_and_b32 v91, 0xffff0000, v64
  v_fma_f32 v90, v90, s14, v13
  v_fma_f32 v91, v91, s14, v13
  v_exp_f32 v90, v90
  v_exp_f32 v91, v91
  v_add_f32 v12, v12, v90
  v_cvt_pk_bf16_f32 v64, v90, v91
  v_add_f32 v12, v12, v91
  s_waitcnt vmcnt(10)
  v_mfma_f32_16x16x32_bf16 v[32:35], v[40:43], v[224:227], v[32:35]
  v_mfma_f32_16x16x32_bf16 v[36:39], v[40:43], v[228:231], v[36:39]
  s_waitcnt vmcnt(6)
  s_cmp_eq_u32 s12, 0
  s_cbranch_scc1 L_pw_43
  s_waitcnt vmcnt(5)
  s_cmp_eq_u32 s12, 1
  s_cbranch_scc1 L_pw_43
  s_waitcnt vmcnt(4)
  L_pw_43:
  s_add_u32 s23, s22, 49152
  buffer_load_dwordx4 v[112:115], v1, s[48:51], s23 offen nt
  buffer_load_dwordx4 v[116:119], v1, s[48:51], s23 offen offset:256 nt
  v_perm_b32 v89, v56, v56, s25
  v_and_b32 v44, v4, v89
  v_and_b32 v45, v5, v89
  v_and_b32 v46, v6, v89
  v_and_b32 v47, v7, v89
  v_lshlrev_b32 v90, 16, v65
  v_and_b32 v91, 0xffff0000, v65
  v_fma_f32 v90, v90, s14, v13
  v_fma_f32 v91, v91, s14, v13
  v_exp_f32 v90, v90
  v_exp_f32 v91, v91
  v_add_f32 v12, v12, v90
  v_cvt_pk_bf16_f32 v65, v90, v91
  v_add_f32 v12, v12, v91
  v_lshlrev_b32 v90, 16, v66
  v_and_b32 v91, 0xffff0000, v66
  v_fma_f32 v90, v90, s14, v13
  v_fma_f32 v91, v91, s14, v13
  v_exp_f32 v90, v90
  v_exp_f32 v91, v91
  v_add_f32 v12, v12, v90
  v_cvt_pk_bf16_f32 v66, v90, v91
  v_add_f32 v12, v12, v91
  v_lshlrev_b32 v90, 16, v67
  v_and_b32 v91, 0xffff0000, v67
  v_fma_f32 v90, v90, s14, v13
  v_fma_f32 v91, v91, s14, v13
  v_exp_f32 v90, v90
  v_exp_f32 v91, v91
  v_add_f32 v12, v12, v90
  v_cvt_pk_bf16_f32 v67, v90, v91
  v_add_f32 v12, v12, v91
  v_lshlrev_b32 v90, 16, v68
  v_and_b32 v91, 0xffff0000, v68
  v_fma_f32 v90, v90, s14, v13
  v_fma_f32 v91, v91, s14, v13
  v_exp_f32 v90, v90
  v_exp_f32 v91, v91
  v_add_f32 v12, v12, v90
  v_cvt_pk_bf16_f32 v68, v90, v91
  v_add_f32 v12, v12, v91
  v_lshlrev_b32 v90, 16, v69
  v_and_b32 v91, 0xffff0000, v69
  v_fma_f32 v90, v90, s14, v13
  v_fma_f32 v91, v91, s14, v13
  v_exp_f32 v90, v90
  v_exp_f32 v91, v91
  v_add_f32 v12, v12, v90
  v_cvt_pk_bf16_f32 v69, v90, v91
  v_add_f32 v12, v12, v91
  v_lshlrev_b32 v90, 16, v70
  v_and_b32 v91, 0xffff0000, v70
  v_fma_f32 v90, v90, s14, v13
  v_fma_f32 v91, v91, s14, v13
  v_exp_f32 v90, v90
  v_exp_f32 v91, v91
  v_add_f32 v12, v12, v90
  v_cvt_pk_bf16_f32 v70, v90, v91
  v_add_f32 v12, v12, v91
  v_lshlrev_b32 v90, 16, v71
  v_and_b32 v91, 0xffff0000, v71
  v_fma_f32 v90, v90, s14, v13
  v_fma_f32 v91, v91, s14, v13
  v_exp_f32 v90, v90
  v_exp_f32 v91, v91
  v_add_f32 v12, v12, v90
  v_cvt_pk_bf16_f32 v71, v90, v91
  v_add_f32 v12, v12, v91
  v_lshlrev_b32 v90, 16, v72
  v_and_b32 v91, 0xffff0000, v72
  v_fma_f32 v90, v90, s14, v13
  v_fma_f32 v91, v91, s14, v13
  v_exp_f32 v90, v90
  v_exp_f32 v91, v91
  v_add_f32 v12, v12, v90
  v_cvt_pk_bf16_f32 v72, v90, v91
  v_add_f32 v12, v12, v91
  s_waitcnt vmcnt(10)
  v_mfma_f32_16x16x32_bf16 v[32:35], v[44:47], v[232:235], v[32:35]
  v_mfma_f32_16x16x32_bf16 v[36:39], v[44:47], v[236:239], v[36:39]
  s_waitcnt vmcnt(6)
  s_cmp_eq_u32 s12, 0
  s_cbranch_scc1 L_pw_44
  s_waitcnt vmcnt(5)
  s_cmp_eq_u32 s12, 1
  s_cbranch_scc1 L_pw_44
  s_waitcnt vmcnt(4)
  L_pw_44:
  s_add_u32 s23, s22, 57344
  buffer_load_dwordx4 v[120:123], v1, s[48:51], s23 offen nt
  buffer_load_dwordx4 v[124:127], v1, s[48:51], s23 offen offset:256 nt
  v_perm_b32 v88, v57, v57, s24
  v_and_b32 v40, v4, v88
  v_and_b32 v41, v5, v88
  v_and_b32 v42, v6, v88
  v_and_b32 v43, v7, v88
  v_lshlrev_b32 v90, 16, v73
  v_and_b32 v91, 0xffff0000, v73
  v_fma_f32 v90, v90, s14, v13
  v_fma_f32 v91, v91, s14, v13
  v_exp_f32 v90, v90
  v_exp_f32 v91, v91
  v_add_f32 v12, v12, v90
  v_cvt_pk_bf16_f32 v73, v90, v91
  v_add_f32 v12, v12, v91
  v_lshlrev_b32 v90, 16, v74
  v_and_b32 v91, 0xffff0000, v74
  v_fma_f32 v90, v90, s14, v13
  v_fma_f32 v91, v91, s14, v13
  v_exp_f32 v90, v90
  v_exp_f32 v91, v91
  v_add_f32 v12, v12, v90
  v_cvt_pk_bf16_f32 v74, v90, v91
  v_add_f32 v12, v12, v91
  v_lshlrev_b32 v90, 16, v75
  v_and_b32 v91, 0xffff0000, v75
  v_fma_f32 v90, v90, s14, v13
  v_fma_f32 v91, v91, s14, v13
  v_exp_f32 v90, v90
  v_exp_f32 v91, v91
  v_add_f32 v12, v12, v90
  v_cvt_pk_bf16_f32 v75, v90, v91
  v_add_f32 v12, v12, v91
  v_lshlrev_b32 v90, 16, v76
  v_and_b32 v91, 0xffff0000, v76
  v_fma_f32 v90, v90, s14, v13
  v_fma_f32 v91, v91, s14, v13
  v_exp_f32 v90, v90
  v_exp_f32 v91, v91
  v_add_f32 v12, v12, v90
  v_cvt_pk_bf16_f32 v76, v90, v91
  v_add_f32 v12, v12, v91
  v_lshlrev_b32 v90, 16, v77
  v_and_b32 v91, 0xffff0000, v77
  v_fma_f32 v90, v90, s14, v13
  v_fma_f32 v91, v91, s14, v13
  v_exp_f32 v90, v90
  v_exp_f32 v91, v91
  v_add_f32 v12, v12, v90
  v_cvt_pk_bf16_f32 v77, v90, v91
  v_add_f32 v12, v12, v91
  v_lshlrev_b32 v90, 16, v78
  v_and_b32 v91, 0xffff0000, v78
  v_fma_f32 v90, v90, s14, v13
  v_fma_f32 v91, v91, s14, v13
  v_exp_f32 v90, v90
  v_exp_f32 v91, v91
  v_add_f32 v12, v12, v90
  v_cvt_pk_bf16_f32 v78, v90, v91
  v_add_f32 v12, v12, v91
  v_lshlrev_b32 v90, 16, v79
  v_and_b32 v91, 0xffff0000, v79
  v_fma_f32 v90, v90, s14, v13
  v_fma_f32 v91, v91, s14, v13
  v_exp_f32 v90, v90
  v_exp_f32 v91, v91
  v_add_f32 v12, v12, v90
  v_cvt_pk_bf16_f32 v79, v90, v91
  v_add_f32 v12, v12, v91
  v_lshlrev_b32 v90, 16, v80
  v_and_b32 v91, 0xffff0000, v80
  v_fma_f32 v90, v90, s14, v13
  v_fma_f32 v91, v91, s14, v13
  v_exp_f32 v90, v90
  v_exp_f32 v91, v91
  v_add_f32 v12, v12, v90
  v_cvt_pk_bf16_f32 v80, v90, v91
  v_add_f32 v12, v12, v91
  s_waitcnt vmcnt(10)
  v_mfma_f32_16x16x32_bf16 v[32:35], v[40:43], v[240:243], v[32:35]
  v_mfma_f32_16x16x32_bf16 v[36:39], v[40:43], v[244:247], v[36:39]
  s_waitcnt vmcnt(6)
  s_cmp_eq_u32 s12, 0
  s_cbranch_scc1 L_pw_45
  s_waitcnt vmcnt(5)
  s_cmp_eq_u32 s12, 1
  s_cbranch_scc1 L_pw_45
  s_waitcnt vmcnt(4)
  L_pw_45:
  s_add_u32 s23, s22, 65536
  buffer_load_dwordx4 v[128:131], v1, s[48:51], s23 offen nt
  buffer_load_dwordx4 v[132:135], v1, s[48:51], s23 offen offset:256 nt
  v_perm_b32 v89, v57, v57, s25
  v_and_b32 v44, v4, v89
  v_and_b32 v45, v5, v89
  v_and_b32 v46, v6, v89
  v_and_b32 v47, v7, v89
  v_lshlrev_b32 v90, 16, v81
  v_and_b32 v91, 0xffff0000, v81
  v_fma_f32 v90, v90, s14, v13
  v_fma_f32 v91, v91, s14, v13
  v_exp_f32 v90, v90
  v_exp_f32 v91, v91
  v_add_f32 v12, v12, v90
  v_cvt_pk_bf16_f32 v81, v90, v91
  v_add_f32 v12, v12, v91
  v_lshlrev_b32 v90, 16, v82
  v_and_b32 v91, 0xffff0000, v82
  v_fma_f32 v90, v90, s14, v13
  v_fma_f32 v91, v91, s14, v13
  v_exp_f32 v90, v90
  v_exp_f32 v91, v91
  v_add_f32 v12, v12, v90
  v_cvt_pk_bf16_f32 v82, v90, v91
  v_add_f32 v12, v12, v91
  v_lshlrev_b32 v90, 16, v83
  v_and_b32 v91, 0xffff0000, v83
  v_fma_f32 v90, v90, s14, v13
  v_fma_f32 v91, v91, s14, v13
  v_exp_f32 v90, v90
  v_exp_f32 v91, v91
  v_add_f32 v12, v12, v90
  v_cvt_pk_bf16_f32 v83, v90, v91
  v_add_f32 v12, v12, v91
  v_lshlrev_b32 v90, 16, v84
  v_and_b32 v91, 0xffff0000, v84
  v_fma_f32 v90, v90, s14, v13
  v_fma_f32 v91, v91, s14, v13
  v_exp_f32 v90, v90
  v_exp_f32 v91, v91
  v_add_f32 v12, v12, v90
  v_cvt_pk_bf16_f32 v84, v90, v91
  v_add_f32 v12, v12, v91
  v_lshlrev_b32 v90, 16, v85
  v_and_b32 v91, 0xffff0000, v85
  v_fma_f32 v90, v90, s14, v13
  v_fma_f32 v91, v91, s14, v13
  v_exp_f32 v90, v90
  v_exp_f32 v91, v91
  v_add_f32 v12, v12, v90
  v_cvt_pk_bf16_f32 v85, v90, v91
  v_add_f32 v12, v12, v91
  v_lshlrev_b32 v90, 16, v86
  v_and_b32 v91, 0xffff0000, v86
  v_fma_f32 v90, v90, s14, v13
  v_fma_f32 v91, v91, s14, v13
  v_exp_f32 v90, v90
  v_exp_f32 v91, v91
  v_add_f32 v12, v12, v90
  v_cvt_pk_bf16_f32 v86, v90, v91
  v_add_f32 v12, v12, v91
  v_lshlrev_b32 v90, 16, v87
  v_and_b32 v91, 0xffff0000, v87
  v_fma_f32 v90, v90, s14, v13
  v_fma_f32 v91, v91, s14, v13
  v_exp_f32 v90, v90
  v_exp_f32 v91, v91
  v_add_f32 v12, v12, v90
  v_cvt_pk_bf16_f32 v87, v90, v91
  v_add_f32 v12, v12, v91
  s_waitcnt vmcnt(10)
  v_mfma_f32_16x16x32_bf16 v[32:35], v[44:47], v[248:251], v[32:35]
  v_mfma_f32_16x16x32_bf16 v[36:39], v[44:47], v[252:255], v[36:39]
  s_waitcnt vmcnt(6)
  s_cmp_eq_u32 s12, 0
  s_cbranch_scc1 L_pw_46
  s_waitcnt vmcnt(5)
  s_cmp_eq_u32 s12, 1
  s_cbranch_scc1 L_pw_46
  s_waitcnt vmcnt(4)
  L_pw_46:
  s_add_u32 s23, s22, 73728
  buffer_load_dwordx4 v[136:139], v1, s[48:51], s23 offen nt
  buffer_load_dwordx4 v[140:143], v1, s[48:51], s23 offen offset:256 nt
  v_perm_b32 v88, v58, v58, s24
  v_and_b32 v40, v4, v88
  v_and_b32 v41, v5, v88
  v_and_b32 v42, v6, v88
  v_and_b32 v43, v7, v88
  v_mov_b32 v14, v12
  s_nop 1
  v_permlane16_swap_b32 v12, v14
  s_nop 1
  v_add_f32 v12, v12, v14
  v_mov_b32 v14, v12
  s_nop 1
  v_permlane32_swap_b32 v12, v14
  s_nop 1
  v_add_f32 v12, v12, v14
  v_and_b32 v14, 8, v2
  s_lshl_b32 s10, s9, 4
  s_add_u32 s10, s10, 140288
  v_add_u32 v14, s10, v14
  v_mov_b32 v92, v11
  v_mov_b32 v93, v12
  ds_write_b64 v14, v[92:93]
  v_mov_b32 v14, 140416
  v_mov_b32 v15, 1
  s_mov_b64 exec, 1
  ds_add_u32 v14, v15
  s_mov_b64 exec, -1
  v_lshrrev_b32 v10, 1, v3
  v_lshlrev_b32 v29, 2, v10
  v_lshlrev_b32 v10, 10, v10
  v_lshl_add_u32 v10, v2, 5, v10
  v_and_b32 v18, 1, v3
  v_lshl_add_u32 v10, v18, 4, v10
  s_lshl_b32 s10, s9, 11
  s_add_u32 s10, s10, 132096
  v_add_u32 v10, s10, v10
  s_lshl_b32 s10, s9, 3
  s_add_u32 s10, s10, 140352
  v_add_u32 v29, s10, v29
  v_lshrrev_b32 v31, 3, v2
  v_lshlrev_b32 v31, 2, v31
  v_add_u32 v31, 140384, v31
  s_nop 0
  s_waitcnt vmcnt(10)
  v_mfma_f32_16x16x32_bf16 v[32:35], v[40:43], v[96:99], v[32:35]
  v_mfma_f32_16x16x32_bf16 v[36:39], v[40:43], v[100:103], v[36:39]
  s_waitcnt vmcnt(6)
  s_cmp_eq_u32 s12, 0
  s_cbranch_scc1 L_pw_47
  s_waitcnt vmcnt(5)
  s_cmp_eq_u32 s12, 1
  s_cbranch_scc1 L_pw_47
  s_waitcnt vmcnt(4)
  L_pw_47:
  s_add_u32 s23, s22, 81920
  buffer_load_dwordx4 v[144:147], v1, s[48:51], s23 offen nt
  buffer_load_dwordx4 v[148:151], v1, s[48:51], s23 offen offset:256 nt
  v_perm_b32 v89, v58, v58, s25
  v_and_b32 v44, v4, v89
  v_and_b32 v45, v5, v89
  v_and_b32 v46, v6, v89
  v_and_b32 v47, v7, v89
  s_nop 0
  s_waitcnt vmcnt(10)
  v_mfma_f32_16x16x32_bf16 v[32:35], v[44:47], v[104:107], v[32:35]
  v_mfma_f32_16x16x32_bf16 v[36:39], v[44:47], v[108:111], v[36:39]
  s_waitcnt vmcnt(6)
  s_cmp_eq_u32 s12, 0
  s_cbranch_scc1 L_pw_48
  s_waitcnt vmcnt(5)
  s_cmp_eq_u32 s12, 1
  s_cbranch_scc1 L_pw_48
  s_waitcnt vmcnt(4)
  L_pw_48:
  s_add_u32 s23, s22, 90112
  buffer_load_dwordx4 v[152:155], v1, s[48:51], s23 offen nt
  buffer_load_dwordx4 v[156:159], v1, s[48:51], s23 offen offset:256 nt
  v_perm_b32 v88, v59, v59, s24
  v_and_b32 v40, v4, v88
  v_and_b32 v41, v5, v88
  v_and_b32 v42, v6, v88
  v_and_b32 v43, v7, v88
  s_nop 0
  s_waitcnt vmcnt(10)
  v_mfma_f32_16x16x32_bf16 v[32:35], v[40:43], v[112:115], v[32:35]
  v_mfma_f32_16x16x32_bf16 v[36:39], v[40:43], v[116:119], v[36:39]
  s_waitcnt vmcnt(6)
  s_cmp_eq_u32 s12, 0
  s_cbranch_scc1 L_pw_49
  s_waitcnt vmcnt(5)
  s_cmp_eq_u32 s12, 1
  s_cbranch_scc1 L_pw_49
  s_waitcnt vmcnt(4)
  L_pw_49:
  s_add_u32 s23, s22, 98304
  buffer_load_dwordx4 v[160:163], v1, s[48:51], s23 offen nt
  buffer_load_dwordx4 v[164:167], v1, s[48:51], s23 offen offset:256 nt
  v_perm_b32 v89, v59, v59, s25
  v_and_b32 v44, v4, v89
  v_and_b32 v45, v5, v89
  v_and_b32 v46, v6, v89
  v_and_b32 v47, v7, v89
  s_nop 0
  s_waitcnt vmcnt(10)
  v_mfma_f32_16x16x32_bf16 v[32:35], v[44:47], v[120:123], v[32:35]
  v_mfma_f32_16x16x32_bf16 v[36:39], v[44:47], v[124:127], v[36:39]
  s_waitcnt vmcnt(6)
  s_cmp_eq_u32 s12, 0
  s_cbranch_scc1 L_pw_50
  s_waitcnt vmcnt(5)
  s_cmp_eq_u32 s12, 1
  s_cbranch_scc1 L_pw_50
  s_waitcnt vmcnt(4)
  L_pw_50:
  s_add_u32 s23, s22, 106496
  buffer_load_dwordx4 v[168:171], v1, s[48:51], s23 offen nt
  buffer_load_dwordx4 v[172:175], v1, s[48:51], s23 offen offset:256 nt
  v_perm_b32 v88, v60, v60, s24
  v_and_b32 v40, v4, v88
  v_and_b32 v41, v5, v88
  v_and_b32 v42, v6, v88
  v_and_b32 v43, v7, v88
  s_nop 0
  s_waitcnt vmcnt(10)
  v_mfma_f32_16x16x32_bf16 v[32:35], v[40:43], v[128:131], v[32:35]
  v_mfma_f32_16x16x32_bf16 v[36:39], v[40:43], v[132:135], v[36:39]
  s_waitcnt vmcnt(6)
  s_cmp_eq_u32 s12, 0
  s_cbranch_scc1 L_pw_51
  s_waitcnt vmcnt(5)
  s_cmp_eq_u32 s12, 1
  s_cbranch_scc1 L_pw_51
  s_waitcnt vmcnt(4)
  L_pw_51:
  s_add_u32 s23, s22, 114688
  buffer_load_dwordx4 v[176:179], v1, s[48:51], s23 offen nt
  buffer_load_dwordx4 v[180:183], v1, s[48:51], s23 offen offset:256 nt
  v_perm_b32 v89, v60, v60, s25
  v_and_b32 v44, v4, v89
  v_and_b32 v45, v5, v89
  v_and_b32 v46, v6, v89
  v_and_b32 v47, v7, v89
  s_nop 0
  s_waitcnt vmcnt(10)
  v_mfma_f32_16x16x32_bf16 v[32:35], v[44:47], v[136:139], v[32:35]
  v_mfma_f32_16x16x32_bf16 v[36:39], v[44:47], v[140:143], v[36:39]
  s_waitcnt vmcnt(6)
  s_cmp_eq_u32 s12, 0
  s_cbranch_scc1 L_pw_52
  s_waitcnt vmcnt(5)
  s_cmp_eq_u32 s12, 1
  s_cbranch_scc1 L_pw_52
  s_waitcnt vmcnt(4)
  L_pw_52:
  s_add_u32 s23, s22, 122880
  buffer_load_dwordx4 v[184:187], v1, s[48:51], s23 offen nt
  buffer_load_dwordx4 v[188:191], v1, s[48:51], s23 offen offset:256 nt
  v_perm_b32 v88, v61, v61, s24
  v_and_b32 v40, v4, v88
  v_and_b32 v41, v5, v88
  v_and_b32 v42, v6, v88
  v_and_b32 v43, v7, v88
  s_nop 0
  s_waitcnt vmcnt(10)
  v_mfma_f32_16x16x32_bf16 v[32:35], v[40:43], v[144:147], v[32:35]
  v_mfma_f32_16x16x32_bf16 v[36:39], v[40:43], v[148:151], v[36:39]
  s_waitcnt vmcnt(6)
  s_cmp_eq_u32 s12, 0
  s_cbranch_scc1 L_pw_53
  s_waitcnt vmcnt(5)
  s_cmp_eq_u32 s12, 1
  s_cbranch_scc1 L_pw_53
  s_waitcnt vmcnt(4)
  L_pw_53:
  s_add_u32 s23, s22, 131072
  buffer_load_dwordx4 v[192:195], v1, s[48:51], s23 offen nt
  buffer_load_dwordx4 v[196:199], v1, s[48:51], s23 offen offset:256 nt
  v_perm_b32 v89, v61, v61, s25
  v_and_b32 v44, v4, v89
  v_and_b32 v45, v5, v89
  v_and_b32 v46, v6, v89
  v_and_b32 v47, v7, v89
  s_nop 0
  s_waitcnt vmcnt(10)
  v_mfma_f32_16x16x32_bf16 v[32:35], v[44:47], v[152:155], v[32:35]
  v_mfma_f32_16x16x32_bf16 v[36:39], v[44:47], v[156:159], v[36:39]
  s_waitcnt vmcnt(6)
  s_cmp_eq_u32 s12, 0
  s_cbranch_scc1 L_pw_54
  s_waitcnt vmcnt(5)
  s_cmp_eq_u32 s12, 1
  s_cbranch_scc1 L_pw_54
  s_waitcnt vmcnt(4)
  L_pw_54:
  s_add_u32 s23, s22, 139264
  buffer_load_dwordx4 v[200:203], v1, s[48:51], s23 offen nt
  buffer_load_dwordx4 v[204:207], v1, s[48:51], s23 offen offset:256 nt
  v_perm_b32 v88, v62, v62, s24
  v_and_b32 v40, v4, v88
  v_and_b32 v41, v5, v88
  v_and_b32 v42, v6, v88
  v_and_b32 v43, v7, v88
  s_nop 0
  s_waitcnt vmcnt(10)
  v_mfma_f32_16x16x32_bf16 v[32:35], v[40:43], v[160:163], v[32:35]
  v_mfma_f32_16x16x32_bf16 v[36:39], v[40:43], v[164:167], v[36:39]
  s_waitcnt vmcnt(6)
  s_cmp_eq_u32 s12, 0
  s_cbranch_scc1 L_pw_55
  s_waitcnt vmcnt(5)
  s_cmp_eq_u32 s12, 1
  s_cbranch_scc1 L_pw_55
  s_waitcnt vmcnt(4)
  L_pw_55:
  s_add_u32 s23, s22, 147456
  buffer_load_dwordx4 v[208:211], v1, s[48:51], s23 offen nt
  buffer_load_dwordx4 v[212:215], v1, s[48:51], s23 offen offset:256 nt
  v_perm_b32 v89, v62, v62, s25
  v_and_b32 v44, v4, v89
  v_and_b32 v45, v5, v89
  v_and_b32 v46, v6, v89
  v_and_b32 v47, v7, v89
  s_nop 0
  s_waitcnt vmcnt(10)
  v_mfma_f32_16x16x32_bf16 v[32:35], v[44:47], v[168:171], v[32:35]
  v_mfma_f32_16x16x32_bf16 v[36:39], v[44:47], v[172:175], v[36:39]
  s_waitcnt vmcnt(6)
  s_cmp_eq_u32 s12, 0
  s_cbranch_scc1 L_pw_56
  s_waitcnt vmcnt(5)
  s_cmp_eq_u32 s12, 1
  s_cbranch_scc1 L_pw_56
  s_waitcnt vmcnt(4)
  L_pw_56:
  s_add_u32 s23, s22, 155648
  buffer_load_dwordx4 v[216:219], v1, s[48:51], s23 offen nt
  buffer_load_dwordx4 v[220:223], v1, s[48:51], s23 offen offset:256 nt
  v_perm_b32 v88, v63, v63, s24
  v_and_b32 v40, v4, v88
  v_and_b32 v41, v5, v88
  v_and_b32 v42, v6, v88
  v_and_b32 v43, v7, v88
  s_nop 0
  s_waitcnt vmcnt(10)
  v_mfma_f32_16x16x32_bf16 v[32:35], v[40:43], v[176:179], v[32:35]
  v_mfma_f32_16x16x32_bf16 v[36:39], v[40:43], v[180:183], v[36:39]
  s_waitcnt vmcnt(6)
  s_cmp_eq_u32 s12, 0
  s_cbranch_scc1 L_pw_57
  s_waitcnt vmcnt(5)
  s_cmp_eq_u32 s12, 1
  s_cbranch_scc1 L_pw_57
  s_waitcnt vmcnt(4)
  L_pw_57:
  s_add_u32 s23, s22, 163840
  buffer_load_dwordx4 v[224:227], v1, s[48:51], s23 offen nt
  buffer_load_dwordx4 v[228:231], v1, s[48:51], s23 offen offset:256 nt
  v_perm_b32 v89, v63, v63, s25
  v_and_b32 v44, v4, v89
  v_and_b32 v45, v5, v89
  v_and_b32 v46, v6, v89
  v_and_b32 v47, v7, v89
  s_nop 0
  s_waitcnt vmcnt(10)
  v_mfma_f32_16x16x32_bf16 v[32:35], v[44:47], v[184:187], v[32:35]
  v_mfma_f32_16x16x32_bf16 v[36:39], v[44:47], v[188:191], v[36:39]
  s_waitcnt vmcnt(6)
  s_cmp_eq_u32 s12, 0
  s_cbranch_scc1 L_pw_58
  s_waitcnt vmcnt(5)
  s_cmp_eq_u32 s12, 1
  s_cbranch_scc1 L_pw_58
  s_waitcnt vmcnt(4)
  L_pw_58:
  s_add_u32 s23, s22, 172032
  buffer_load_dwordx4 v[232:235], v1, s[48:51], s23 offen nt
  buffer_load_dwordx4 v[236:239], v1, s[48:51], s23 offen offset:256 nt
  v_perm_b32 v88, v64, v64, s24
  v_and_b32 v40, v4, v88
  v_and_b32 v41, v5, v88
  v_and_b32 v42, v6, v88
  v_and_b32 v43, v7, v88
  s_nop 0
  s_waitcnt vmcnt(10)
  v_mfma_f32_16x16x32_bf16 v[32:35], v[40:43], v[192:195], v[32:35]
  v_mfma_f32_16x16x32_bf16 v[36:39], v[40:43], v[196:199], v[36:39]
  s_waitcnt vmcnt(6)
  s_cmp_eq_u32 s12, 0
  s_cbranch_scc1 L_pw_59
  s_waitcnt vmcnt(5)
  s_cmp_eq_u32 s12, 1
  s_cbranch_scc1 L_pw_59
  s_waitcnt vmcnt(4)
  L_pw_59:
  s_add_u32 s23, s22, 180224
  buffer_load_dwordx4 v[240:243], v1, s[48:51], s23 offen nt
  buffer_load_dwordx4 v[244:247], v1, s[48:51], s23 offen offset:256 nt
  v_perm_b32 v89, v64, v64, s25
  v_and_b32 v44, v4, v89
  v_and_b32 v45, v5, v89
  v_and_b32 v46, v6, v89
  v_and_b32 v47, v7, v89
  s_nop 0
  s_waitcnt vmcnt(10)
  v_mfma_f32_16x16x32_bf16 v[32:35], v[44:47], v[200:203], v[32:35]
  v_mfma_f32_16x16x32_bf16 v[36:39], v[44:47], v[204:207], v[36:39]
  s_waitcnt vmcnt(6)
  s_cmp_eq_u32 s12, 0
  s_cbranch_scc1 L_pw_60
  s_waitcnt vmcnt(5)
  s_cmp_eq_u32 s12, 1
  s_cbranch_scc1 L_pw_60
  s_waitcnt vmcnt(4)
  L_pw_60:
  s_add_u32 s23, s22, 188416
  buffer_load_dwordx4 v[248:251], v1, s[48:51], s23 offen nt
  buffer_load_dwordx4 v[252:255], v1, s[48:51], s23 offen offset:256 nt
  v_perm_b32 v88, v65, v65, s24
  v_and_b32 v40, v4, v88
  v_and_b32 v41, v5, v88
  v_and_b32 v42, v6, v88
  v_and_b32 v43, v7, v88
  s_nop 0
  s_waitcnt vmcnt(10)
  v_mfma_f32_16x16x32_bf16 v[32:35], v[40:43], v[208:211], v[32:35]
  v_mfma_f32_16x16x32_bf16 v[36:39], v[40:43], v[212:215], v[36:39]
  s_waitcnt vmcnt(6)
  s_cmp_eq_u32 s12, 0
  s_cbranch_scc1 L_pw_61
  s_waitcnt vmcnt(5)
  s_cmp_eq_u32 s12, 1
  s_cbranch_scc1 L_pw_61
  s_waitcnt vmcnt(4)
  L_pw_61:
  s_add_u32 s23, s22, 196608
  buffer_load_dwordx4 v[96:99], v1, s[48:51], s23 offen nt
  buffer_load_dwordx4 v[100:103], v1, s[48:51], s23 offen offset:256 nt
  v_perm_b32 v89, v65, v65, s25
  v_and_b32 v44, v4, v89
  v_and_b32 v45, v5, v89
  v_and_b32 v46, v6, v89
  v_and_b32 v47, v7, v89
  s_nop 0
  s_waitcnt vmcnt(10)
  v_mfma_f32_16x16x32_bf16 v[32:35], v[44:47], v[216:219], v[32:35]
  v_mfma_f32_16x16x32_bf16 v[36:39], v[44:47], v[220:223], v[36:39]
  s_waitcnt vmcnt(6)
  s_cmp_eq_u32 s12, 0
  s_cbranch_scc1 L_pw_62
  s_waitcnt vmcnt(5)
  s_cmp_eq_u32 s12, 1
  s_cbranch_scc1 L_pw_62
  s_waitcnt vmcnt(4)
  L_pw_62:
  s_add_u32 s23, s22, 204800
  buffer_load_dwordx4 v[104:107], v1, s[48:51], s23 offen nt
  buffer_load_dwordx4 v[108:111], v1, s[48:51], s23 offen offset:256 nt
  v_perm_b32 v88, v66, v66, s24
  v_and_b32 v40, v4, v88
  v_and_b32 v41, v5, v88
  v_and_b32 v42, v6, v88
  v_and_b32 v43, v7, v88
  s_nop 0
  s_waitcnt vmcnt(10)
  v_mfma_f32_16x16x32_bf16 v[32:35], v[40:43], v[224:227], v[32:35]
  v_mfma_f32_16x16x32_bf16 v[36:39], v[40:43], v[228:231], v[36:39]
  s_waitcnt vmcnt(6)
  s_cmp_eq_u32 s12, 0
  s_cbranch_scc1 L_pw_63
  s_waitcnt vmcnt(5)
  s_cmp_eq_u32 s12, 1
  s_cbranch_scc1 L_pw_63
  s_waitcnt vmcnt(4)
  L_pw_63:
  s_add_u32 s23, s22, 212992
  buffer_load_dwordx4 v[112:115], v1, s[48:51], s23 offen nt
  buffer_load_dwordx4 v[116:119], v1, s[48:51], s23 offen offset:256 nt
  v_perm_b32 v89, v66, v66, s25
  v_and_b32 v44, v4, v89
  v_and_b32 v45, v5, v89
  v_and_b32 v46, v6, v89
  v_and_b32 v47, v7, v89
  s_nop 0
  s_waitcnt vmcnt(10)
  v_mfma_f32_16x16x32_bf16 v[32:35], v[44:47], v[232:235], v[32:35]
  v_mfma_f32_16x16x32_bf16 v[36:39], v[44:47], v[236:239], v[36:39]
  s_waitcnt vmcnt(6)
  s_cmp_eq_u32 s12, 0
  s_cbranch_scc1 L_pw_64
  s_waitcnt vmcnt(5)
  s_cmp_eq_u32 s12, 1
  s_cbranch_scc1 L_pw_64
  s_waitcnt vmcnt(4)
  L_pw_64:
  s_add_u32 s23, s22, 221184
  buffer_load_dwordx4 v[120:123], v1, s[48:51], s23 offen nt
  buffer_load_dwordx4 v[124:127], v1, s[48:51], s23 offen offset:256 nt
  v_perm_b32 v88, v67, v67, s24
  v_and_b32 v40, v4, v88
  v_and_b32 v41, v5, v88
  v_and_b32 v42, v6, v88
  v_and_b32 v43, v7, v88
  s_nop 0
  s_waitcnt vmcnt(10)
  v_mfma_f32_16x16x32_bf16 v[32:35], v[40:43], v[240:243], v[32:35]
  v_mfma_f32_16x16x32_bf16 v[36:39], v[40:43], v[244:247], v[36:39]
  s_waitcnt vmcnt(6)
  s_cmp_eq_u32 s12, 0
  s_cbranch_scc1 L_pw_65
  s_waitcnt vmcnt(5)
  s_cmp_eq_u32 s12, 1
  s_cbranch_scc1 L_pw_65
  s_waitcnt vmcnt(4)
  L_pw_65:
  s_add_u32 s23, s22, 229376
  buffer_load_dwordx4 v[128:131], v1, s[48:51], s23 offen nt
  buffer_load_dwordx4 v[132:135], v1, s[48:51], s23 offen offset:256 nt
  v_perm_b32 v89, v67, v67, s25
  v_and_b32 v44, v4, v89
  v_and_b32 v45, v5, v89
  v_and_b32 v46, v6, v89
  v_and_b32 v47, v7, v89
  s_nop 0
  s_waitcnt vmcnt(10)
  v_mfma_f32_16x16x32_bf16 v[32:35], v[44:47], v[248:251], v[32:35]
  v_mfma_f32_16x16x32_bf16 v[36:39], v[44:47], v[252:255], v[36:39]
  s_waitcnt vmcnt(6)
  s_cmp_eq_u32 s12, 0
  s_cbranch_scc1 L_pw_66
  s_waitcnt vmcnt(5)
  s_cmp_eq_u32 s12, 1
  s_cbranch_scc1 L_pw_66
  s_waitcnt vmcnt(4)
  L_pw_66:
  s_add_u32 s23, s22, 237568
  buffer_load_dwordx4 v[136:139], v1, s[48:51], s23 offen nt
  buffer_load_dwordx4 v[140:143], v1, s[48:51], s23 offen offset:256 nt
  v_perm_b32 v88, v68, v68, s24
  v_and_b32 v40, v4, v88
  v_and_b32 v41, v5, v88
  v_and_b32 v42, v6, v88
  v_and_b32 v43, v7, v88
  s_nop 0
  s_waitcnt vmcnt(10)
  v_mfma_f32_16x16x32_bf16 v[32:35], v[40:43], v[96:99], v[32:35]
  v_mfma_f32_16x16x32_bf16 v[36:39], v[40:43], v[100:103], v[36:39]
  s_waitcnt vmcnt(6)
  s_cmp_eq_u32 s12, 0
  s_cbranch_scc1 L_pw_67
  s_waitcnt vmcnt(5)
  s_cmp_eq_u32 s12, 1
  s_cbranch_scc1 L_pw_67
  s_waitcnt vmcnt(4)
  L_pw_67:
  s_add_u32 s23, s22, 245760
  buffer_load_dwordx4 v[144:147], v1, s[48:51], s23 offen nt
  buffer_load_dwordx4 v[148:151], v1, s[48:51], s23 offen offset:256 nt
  v_perm_b32 v89, v68, v68, s25
  v_and_b32 v44, v4, v89
  v_and_b32 v45, v5, v89
  v_and_b32 v46, v6, v89
  v_and_b32 v47, v7, v89
  s_nop 0
  s_waitcnt vmcnt(10)
  v_mfma_f32_16x16x32_bf16 v[32:35], v[44:47], v[104:107], v[32:35]
  v_mfma_f32_16x16x32_bf16 v[36:39], v[44:47], v[108:111], v[36:39]
  s_waitcnt vmcnt(6)
  s_cmp_eq_u32 s12, 0
  s_cbranch_scc1 L_pw_68
  s_waitcnt vmcnt(5)
  s_cmp_eq_u32 s12, 1
  s_cbranch_scc1 L_pw_68
  s_waitcnt vmcnt(4)
  L_pw_68:
  s_add_u32 s23, s22, 253952
  buffer_load_dwordx4 v[152:155], v1, s[48:51], s23 offen nt
  buffer_load_dwordx4 v[156:159], v1, s[48:51], s23 offen offset:256 nt
  v_perm_b32 v88, v69, v69, s24
  v_and_b32 v40, v4, v88
  v_and_b32 v41, v5, v88
  v_and_b32 v42, v6, v88
  v_and_b32 v43, v7, v88
  s_nop 0
  s_waitcnt vmcnt(10)
  v_mfma_f32_16x16x32_bf16 v[32:35], v[40:43], v[112:115], v[32:35]
  v_mfma_f32_16x16x32_bf16 v[36:39], v[40:43], v[116:119], v[36:39]
  s_waitcnt vmcnt(6)
  s_cmp_eq_u32 s12, 0
  s_cbranch_scc1 L_pw_69
  s_waitcnt vmcnt(5)
  s_cmp_eq_u32 s12, 1
  s_cbranch_scc1 L_pw_69
  s_waitcnt vmcnt(4)
  L_pw_69:
  s_add_u32 s23, s22, 262144
  buffer_load_dwordx4 v[160:163], v1, s[48:51], s23 offen nt
  buffer_load_dwordx4 v[164:167], v1, s[48:51], s23 offen offset:256 nt
  v_perm_b32 v89, v69, v69, s25
  v_and_b32 v44, v4, v89
  v_and_b32 v45, v5, v89
  v_and_b32 v46, v6, v89
  v_and_b32 v47, v7, v89
  s_nop 0
  s_waitcnt vmcnt(10)
  v_mfma_f32_16x16x32_bf16 v[32:35], v[44:47], v[120:123], v[32:35]
  v_mfma_f32_16x16x32_bf16 v[36:39], v[44:47], v[124:127], v[36:39]
  s_waitcnt vmcnt(6)
  s_cmp_eq_u32 s12, 0
  s_cbranch_scc1 L_pw_70
  s_waitcnt vmcnt(5)
  s_cmp_eq_u32 s12, 1
  s_cbranch_scc1 L_pw_70
  s_waitcnt vmcnt(4)
  L_pw_70:
  s_add_u32 s23, s22, 270336
  buffer_load_dwordx4 v[168:171], v1, s[48:51], s23 offen nt
  buffer_load_dwordx4 v[172:175], v1, s[48:51], s23 offen offset:256 nt
  v_perm_b32 v88, v70, v70, s24
  v_and_b32 v40, v4, v88
  v_and_b32 v41, v5, v88
  v_and_b32 v42, v6, v88
  v_and_b32 v43, v7, v88
  s_nop 0
  s_waitcnt vmcnt(10)
  v_mfma_f32_16x16x32_bf16 v[32:35], v[40:43], v[128:131], v[32:35]
  v_mfma_f32_16x16x32_bf16 v[36:39], v[40:43], v[132:135], v[36:39]
  s_waitcnt vmcnt(6)
  s_cmp_eq_u32 s12, 0
  s_cbranch_scc1 L_pw_71
  s_waitcnt vmcnt(5)
  s_cmp_eq_u32 s12, 1
  s_cbranch_scc1 L_pw_71
  s_waitcnt vmcnt(4)
  L_pw_71:
  s_add_u32 s23, s22, 278528
  buffer_load_dwordx4 v[176:179], v1, s[48:51], s23 offen nt
  buffer_load_dwordx4 v[180:183], v1, s[48:51], s23 offen offset:256 nt
  v_perm_b32 v89, v70, v70, s25
  v_and_b32 v44, v4, v89
  v_and_b32 v45, v5, v89
  v_and_b32 v46, v6, v89
  v_and_b32 v47, v7, v89
  s_nop 0
  s_waitcnt vmcnt(10)
  v_mfma_f32_16x16x32_bf16 v[32:35], v[44:47], v[136:139], v[32:35]
  v_mfma_f32_16x16x32_bf16 v[36:39], v[44:47], v[140:143], v[36:39]
  s_waitcnt vmcnt(6)
  s_cmp_eq_u32 s12, 0
  s_cbranch_scc1 L_pw_72
  s_waitcnt vmcnt(5)
  s_cmp_eq_u32 s12, 1
  s_cbranch_scc1 L_pw_72
  s_waitcnt vmcnt(4)
  L_pw_72:
  s_add_u32 s23, s22, 286720
  buffer_load_dwordx4 v[184:187], v1, s[48:51], s23 offen nt
  buffer_load_dwordx4 v[188:191], v1, s[48:51], s23 offen offset:256 nt
  v_perm_b32 v88, v71, v71, s24
  v_and_b32 v40, v4, v88
  v_and_b32 v41, v5, v88
  v_and_b32 v42, v6, v88
  v_and_b32 v43, v7, v88
  s_nop 0
  s_waitcnt vmcnt(10)
  v_mfma_f32_16x16x32_bf16 v[32:35], v[40:43], v[144:147], v[32:35]
  v_mfma_f32_16x16x32_bf16 v[36:39], v[40:43], v[148:151], v[36:39]
  s_waitcnt vmcnt(6)
  s_cmp_eq_u32 s12, 0
  s_cbranch_scc1 L_pw_73
  s_waitcnt vmcnt(5)
  s_cmp_eq_u32 s12, 1
  s_cbranch_scc1 L_pw_73
  s_waitcnt vmcnt(4)
  L_pw_73:
  s_add_u32 s23, s22, 294912
  buffer_load_dwordx4 v[192:195], v1, s[48:51], s23 offen nt
  buffer_load_dwordx4 v[196:199], v1, s[48:51], s23 offen offset:256 nt
  v_perm_b32 v89, v71, v71, s25
  v_and_b32 v44, v4, v89
  v_and_b32 v45, v5, v89
  v_and_b32 v46, v6, v89
  v_and_b32 v47, v7, v89
  s_nop 0
  s_waitcnt vmcnt(10)
  v_mfma_f32_16x16x32_bf16 v[32:35], v[44:47], v[152:155], v[32:35]
  v_mfma_f32_16x16x32_bf16 v[36:39], v[44:47], v[156:159], v[36:39]
  s_waitcnt vmcnt(6)
  s_cmp_eq_u32 s12, 0
  s_cbranch_scc1 L_pw_74
  s_waitcnt vmcnt(5)
  s_cmp_eq_u32 s12, 1
  s_cbranch_scc1 L_pw_74
  s_waitcnt vmcnt(4)
  L_pw_74:
  s_add_u32 s23, s22, 303104
  buffer_load_dwordx4 v[200:203], v1, s[48:51], s23 offen nt
  buffer_load_dwordx4 v[204:207], v1, s[48:51], s23 offen offset:256 nt
  v_perm_b32 v88, v72, v72, s24
  v_and_b32 v40, v4, v88
  v_and_b32 v41, v5, v88
  v_and_b32 v42, v6, v88
  v_and_b32 v43, v7, v88
  s_nop 0
  s_waitcnt vmcnt(10)
  v_mfma_f32_16x16x32_bf16 v[32:35], v[40:43], v[160:163], v[32:35]
  v_mfma_f32_16x16x32_bf16 v[36:39], v[40:43], v[164:167], v[36:39]
  s_waitcnt vmcnt(6)
  s_cmp_eq_u32 s12, 0
  s_cbranch_scc1 L_pw_75
  s_waitcnt vmcnt(5)
  s_cmp_eq_u32 s12, 1
  s_cbranch_scc1 L_pw_75
  s_waitcnt vmcnt(4)
  L_pw_75:
  s_add_u32 s23, s22, 311296
  buffer_load_dwordx4 v[208:211], v1, s[48:51], s23 offen nt
  buffer_load_dwordx4 v[212:215], v1, s[48:51], s23 offen offset:256 nt
  v_perm_b32 v89, v72, v72, s25
  v_and_b32 v44, v4, v89
  v_and_b32 v45, v5, v89
  v_and_b32 v46, v6, v89
  v_and_b32 v47, v7, v89
  s_nop 0
  s_waitcnt vmcnt(10)
  v_mfma_f32_16x16x32_bf16 v[32:35], v[44:47], v[168:171], v[32:35]
  v_mfma_f32_16x16x32_bf16 v[36:39], v[44:47], v[172:175], v[36:39]
  s_waitcnt vmcnt(6)
  s_cmp_eq_u32 s12, 0
  s_cbranch_scc1 L_pw_76
  s_waitcnt vmcnt(5)
  s_cmp_eq_u32 s12, 1
  s_cbranch_scc1 L_pw_76
  s_waitcnt vmcnt(4)
  L_pw_76:
  s_add_u32 s23, s22, 319488
  buffer_load_dwordx4 v[216:219], v1, s[48:51], s23 offen nt
  buffer_load_dwordx4 v[220:223], v1, s[48:51], s23 offen offset:256 nt
  v_perm_b32 v88, v73, v73, s24
  v_and_b32 v40, v4, v88
  v_and_b32 v41, v5, v88
  v_and_b32 v42, v6, v88
  v_and_b32 v43, v7, v88
  s_nop 0
  s_waitcnt vmcnt(10)
  v_mfma_f32_16x16x32_bf16 v[32:35], v[40:43], v[176:179], v[32:35]
  v_mfma_f32_16x16x32_bf16 v[36:39], v[40:43], v[180:183], v[36:39]
  s_waitcnt vmcnt(6)
  s_cmp_eq_u32 s12, 0
  s_cbranch_scc1 L_pw_77
  s_waitcnt vmcnt(5)
  s_cmp_eq_u32 s12, 1
  s_cbranch_scc1 L_pw_77
  s_waitcnt vmcnt(4)
  L_pw_77:
  s_add_u32 s23, s22, 327680
  buffer_load_dwordx4 v[224:227], v1, s[48:51], s23 offen nt
  buffer_load_dwordx4 v[228:231], v1, s[48:51], s23 offen offset:256 nt
  v_perm_b32 v89, v73, v73, s25
  v_and_b32 v44, v4, v89
  v_and_b32 v45, v5, v89
  v_and_b32 v46, v6, v89
  v_and_b32 v47, v7, v89
  s_nop 0
  s_waitcnt vmcnt(10)
  v_mfma_f32_16x16x32_bf16 v[32:35], v[44:47], v[184:187], v[32:35]
  v_mfma_f32_16x16x32_bf16 v[36:39], v[44:47], v[188:191], v[36:39]
  s_waitcnt vmcnt(6)
  s_cmp_eq_u32 s12, 0
  s_cbranch_scc1 L_pw_78
  s_waitcnt vmcnt(5)
  s_cmp_eq_u32 s12, 1
  s_cbranch_scc1 L_pw_78
  s_waitcnt vmcnt(4)
  L_pw_78:
  s_add_u32 s23, s22, 335872
  buffer_load_dwordx4 v[232:235], v1, s[48:51], s23 offen nt
  buffer_load_dwordx4 v[236:239], v1, s[48:51], s23 offen offset:256 nt
  v_perm_b32 v88, v74, v74, s24
  v_and_b32 v40, v4, v88
  v_and_b32 v41, v5, v88
  v_and_b32 v42, v6, v88
  v_and_b32 v43, v7, v88
  s_nop 0
  s_waitcnt vmcnt(10)
  v_mfma_f32_16x16x32_bf16 v[32:35], v[40:43], v[192:195], v[32:35]
  v_mfma_f32_16x16x32_bf16 v[36:39], v[40:43], v[196:199], v[36:39]
  s_waitcnt vmcnt(6)
  s_cmp_eq_u32 s12, 0
  s_cbranch_scc1 L_pw_79
  s_waitcnt vmcnt(5)
  s_cmp_eq_u32 s12, 1
  s_cbranch_scc1 L_pw_79
  s_waitcnt vmcnt(4)
  L_pw_79:
  s_add_u32 s23, s22, 344064
  buffer_load_dwordx4 v[240:243], v1, s[48:51], s23 offen nt
  buffer_load_dwordx4 v[244:247], v1, s[48:51], s23 offen offset:256 nt
  v_perm_b32 v89, v74, v74, s25
  v_and_b32 v44, v4, v89
  v_and_b32 v45, v5, v89
  v_and_b32 v46, v6, v89
  v_and_b32 v47, v7, v89
  s_nop 0
  s_waitcnt vmcnt(10)
  v_mfma_f32_16x16x32_bf16 v[32:35], v[44:47], v[200:203], v[32:35]
  v_mfma_f32_16x16x32_bf16 v[36:39], v[44:47], v[204:207], v[36:39]
  s_waitcnt vmcnt(6)
  s_cmp_eq_u32 s12, 0
  s_cbranch_scc1 L_pw_80
  s_waitcnt vmcnt(5)
  s_cmp_eq_u32 s12, 1
  s_cbranch_scc1 L_pw_80
  s_waitcnt vmcnt(4)
  L_pw_80:
  s_add_u32 s23, s22, 352256
  buffer_load_dwordx4 v[248:251], v1, s[48:51], s23 offen nt
  buffer_load_dwordx4 v[252:255], v1, s[48:51], s23 offen offset:256 nt
  v_perm_b32 v88, v75, v75, s24
  v_and_b32 v40, v4, v88
  v_and_b32 v41, v5, v88
  v_and_b32 v42, v6, v88
  v_and_b32 v43, v7, v88
  s_nop 0
  s_waitcnt vmcnt(10)
  v_mfma_f32_16x16x32_bf16 v[32:35], v[40:43], v[208:211], v[32:35]
  v_mfma_f32_16x16x32_bf16 v[36:39], v[40:43], v[212:215], v[36:39]
  s_waitcnt vmcnt(6)
  s_cmp_eq_u32 s12, 0
  s_cbranch_scc1 L_pw_81
  s_waitcnt vmcnt(5)
  s_cmp_eq_u32 s12, 1
  s_cbranch_scc1 L_pw_81
  s_waitcnt vmcnt(4)
  L_pw_81:
  s_add_u32 s23, s22, 360448
  buffer_load_dwordx4 v[96:99], v1, s[48:51], s23 offen nt
  buffer_load_dwordx4 v[100:103], v1, s[48:51], s23 offen offset:256 nt
  v_mov_b32 v50, 1
  s_mov_b64 exec, 1
  buffer_atomic_add v50, v17, s[88:91], s26 offen sc0 sc1
  s_mov_b64 exec, -1
  v_perm_b32 v89, v75, v75, s25
  v_and_b32 v44, v4, v89
  v_and_b32 v45, v5, v89
  v_and_b32 v46, v6, v89
  v_and_b32 v47, v7, v89
  s_nop 0
  s_waitcnt vmcnt(11)
  v_mfma_f32_16x16x32_bf16 v[32:35], v[44:47], v[216:219], v[32:35]
  v_mfma_f32_16x16x32_bf16 v[36:39], v[44:47], v[220:223], v[36:39]
  s_waitcnt vmcnt(6)
  s_cmp_eq_u32 s12, 0
  s_cbranch_scc1 L_pw_82
  s_waitcnt vmcnt(5)
  s_cmp_eq_u32 s12, 1
  s_cbranch_scc1 L_pw_82
  s_waitcnt vmcnt(4)
  L_pw_82:
  s_add_u32 s23, s22, 368640
  buffer_load_dwordx4 v[104:107], v1, s[48:51], s23 offen nt
  buffer_load_dwordx4 v[108:111], v1, s[48:51], s23 offen offset:256 nt
  v_perm_b32 v88, v76, v76, s24
  v_and_b32 v40, v4, v88
  v_and_b32 v41, v5, v88
  v_and_b32 v42, v6, v88
  v_and_b32 v43, v7, v88
  s_nop 0
  s_waitcnt vmcnt(11)
  v_mfma_f32_16x16x32_bf16 v[32:35], v[40:43], v[224:227], v[32:35]
  v_mfma_f32_16x16x32_bf16 v[36:39], v[40:43], v[228:231], v[36:39]
  s_waitcnt vmcnt(6)
  s_cmp_eq_u32 s12, 0
  s_cbranch_scc1 L_pw_83
  s_waitcnt vmcnt(5)
  s_cmp_eq_u32 s12, 1
  s_cbranch_scc1 L_pw_83
  s_waitcnt vmcnt(4)
  L_pw_83:
  s_add_u32 s23, s22, 376832
  buffer_load_dwordx4 v[112:115], v1, s[48:51], s23 offen nt
  buffer_load_dwordx4 v[116:119], v1, s[48:51], s23 offen offset:256 nt
  v_mov_b32 v51, 1
  s_mov_b64 exec, 1
  buffer_atomic_add v51, v17, s[88:91], s26 offen sc0 sc1
  s_mov_b64 exec, -1
  v_perm_b32 v89, v76, v76, s25
  v_and_b32 v44, v4, v89
  v_and_b32 v45, v5, v89
  v_and_b32 v46, v6, v89
  v_and_b32 v47, v7, v89
  s_nop 0
  s_waitcnt vmcnt(12)
  v_mfma_f32_16x16x32_bf16 v[32:35], v[44:47], v[232:235], v[32:35]
  v_mfma_f32_16x16x32_bf16 v[36:39], v[44:47], v[236:239], v[36:39]
  s_waitcnt vmcnt(6)
  s_cmp_eq_u32 s12, 0
  s_cbranch_scc1 L_pw_84
  s_waitcnt vmcnt(5)
  s_cmp_eq_u32 s12, 1
  s_cbranch_scc1 L_pw_84
  s_waitcnt vmcnt(4)
  L_pw_84:
  s_add_u32 s23, s22, 385024
  buffer_load_dwordx4 v[120:123], v1, s[48:51], s23 offen nt
  buffer_load_dwordx4 v[124:127], v1, s[48:51], s23 offen offset:256 nt
  v_perm_b32 v88, v77, v77, s24
  v_and_b32 v40, v4, v88
  v_and_b32 v41, v5, v88
  v_and_b32 v42, v6, v88
  v_and_b32 v43, v7, v88
  s_nop 0
  s_waitcnt vmcnt(12)
  v_mfma_f32_16x16x32_bf16 v[32:35], v[40:43], v[240:243], v[32:35]
  v_mfma_f32_16x16x32_bf16 v[36:39], v[40:43], v[244:247], v[36:39]
  v_mov_b32 v18, 140420
  s_mov_b32 s15, 1048576
L_lw_85:
  ds_read_b32 v19, v18
  s_waitcnt lgkmcnt(0)
  v_cmp_gt_u32 vcc, 1, v19
  s_cbranch_vccz L_lwd_86
  s_sleep 2
  s_sub_u32 s15, s15, 1
  s_cmp_lg_u32 s15, 0
  s_cbranch_scc1 L_lw_85
L_lwd_86:
  ds_read_b32 v28, v29
  ds_read_b32 v30, v31
  s_waitcnt vmcnt(6)
  v_readfirstlane_b32 s68, v50
  s_nop 3
  s_add_u32 s68, s68, 1
  s_mov_b32 s71, s68
  s_bfe_u32 s69, s68, 0x30002
  s_lshr_b32 s70, s68, 5
  s_and_b32 s10, s68, 3
  s_lshl2_add_u32 s70, s70, s10
  s_lshl_b32 s23, s69, 7
  s_add_u32 s23, s23, s28
  s_lshl_b32 s69, s69, 14
  s_add_u32 s69, s69, s27
  s_and_b32 s10, s70, 3
  s_lshl_b32 s11, s10, 5
  s_add_u32 s23, s23, s11
  s_lshl_b32 s10, s10, 12
  s_add_u32 s69, s69, s10
  s_lshr_b32 s70, s70, 2
  s_lshl_b32 s11, s70, 11
  s_add_u32 s23, s23, s11
  s_lshl_b32 s70, s70, 19
  s_add_u32 s69, s69, s70
  s_cmp_lt_u32 s68, 128
  s_cselect_b32 s69, s69, 0x7ff00000
  s_cselect_b32 s60, s23, 0x7ff00000
  s_cselect_b32 s72, s24, 0x0c0c0c0c
  s_cselect_b32 s73, s25, 0x0c0c0c0c
  s_add_u32 s70, s69, 2048
  v_mov_b32 v48, 1
  s_mov_b64 exec, 1
  buffer_atomic_add v48, v17, s[88:91], s26 offen sc0 sc1
  s_mov_b64 exec, -1
  buffer_load_dword v20, v16, s[88:91], s60 offen sc1
  buffer_load_dwordx4 v[128:131], v1, s[48:51], s69 offen nt
  buffer_load_dwordx4 v[132:135], v1, s[48:51], s69 offen offset:256 nt
  buffer_load_dwordx4 v[136:139], v1, s[48:51], s70 offen nt
  buffer_load_dwordx4 v[140:143], v1, s[48:51], s70 offen offset:256 nt
  v_perm_b32 v89, v77, v77, s25
  v_and_b32 v44, v4, v89
  v_and_b32 v45, v5, v89
  v_and_b32 v46, v6, v89
  v_and_b32 v47, v7, v89
  s_nop 0
  s_waitcnt vmcnt(16)
  v_mfma_f32_16x16x32_bf16 v[32:35], v[44:47], v[248:251], v[32:35]
  v_mfma_f32_16x16x32_bf16 v[36:39], v[44:47], v[252:255], v[36:39]
  v_perm_b32 v88, v78, v78, s24
  v_and_b32 v40, v4, v88
  v_and_b32 v41, v5, v88
  v_and_b32 v42, v6, v88
  v_and_b32 v43, v7, v88
  s_nop 0
  s_waitcnt vmcnt(14)
  v_mfma_f32_16x16x32_bf16 v[32:35], v[40:43], v[96:99], v[32:35]
  v_mfma_f32_16x16x32_bf16 v[36:39], v[40:43], v[100:103], v[36:39]
  s_waitcnt vmcnt(6)
  v_readfirstlane_b32 s68, v51
  s_nop 3
  s_add_u32 s68, s68, 1
  s_bfe_u32 s69, s68, 0x30002
  s_lshr_b32 s70, s68, 5
  s_and_b32 s10, s68, 3
  s_lshl2_add_u32 s70, s70, s10
  s_lshl_b32 s23, s69, 7
  s_add_u32 s23, s23, s28
  s_lshl_b32 s69, s69, 14
  s_add_u32 s69, s69, s27
  s_and_b32 s10, s70, 3
  s_lshl_b32 s11, s10, 5
  s_add_u32 s23, s23, s11
  s_lshl_b32 s10, s10, 12
  s_add_u32 s69, s69, s10
  s_lshr_b32 s70, s70, 2
  s_lshl_b32 s11, s70, 11
  s_add_u32 s23, s23, s11
  s_lshl_b32 s70, s70, 19
  s_add_u32 s69, s69, s70
  s_cmp_lt_u32 s68, 128
  s_cselect_b32 s69, s69, 0x7ff00000
  s_cselect_b32 s61, s23, 0x7ff00000
  s_cselect_b32 s74, s24, 0x0c0c0c0c
  s_cselect_b32 s75, s25, 0x0c0c0c0c
  s_add_u32 s70, s69, 2048
  v_mov_b32 v49, 1
  s_mov_b64 exec, 1
  buffer_atomic_add v49, v17, s[88:91], s26 offen sc0 sc1
  s_mov_b64 exec, -1
  buffer_load_dword v21, v16, s[88:91], s61 offen sc1
  buffer_load_dwordx4 v[144:147], v1, s[48:51], s69 offen nt
  buffer_load_dwordx4 v[148:151], v1, s[48:51], s69 offen offset:256 nt
  buffer_load_dwordx4 v[152:155], v1, s[48:51], s70 offen nt
  buffer_load_dwordx4 v[156:159], v1, s[48:51], s70 offen offset:256 nt
  v_perm_b32 v89, v78, v78, s25
  v_and_b32 v44, v4, v89
  v_and_b32 v45, v5, v89
  v_and_b32 v46, v6, v89
  v_and_b32 v47, v7, v89
  s_nop 0
  s_waitcnt vmcnt(17)
  v_mfma_f32_16x16x32_bf16 v[32:35], v[44:47], v[104:107], v[32:35]
  v_mfma_f32_16x16x32_bf16 v[36:39], v[44:47], v[108:111], v[36:39]
  v_perm_b32 v88, v79, v79, s24
  v_and_b32 v40, v4, v88
  v_and_b32 v41, v5, v88
  v_and_b32 v42, v6, v88
  v_and_b32 v43, v7, v88
  s_nop 0
  s_waitcnt vmcnt(15)
  v_mfma_f32_16x16x32_bf16 v[32:35], v[40:43], v[112:115], v[32:35]
  v_mfma_f32_16x16x32_bf16 v[36:39], v[40:43], v[116:119], v[36:39]
  s_waitcnt vmcnt(6)
  v_readfirstlane_b32 s68, v48
  s_nop 3
  s_add_u32 s68, s68, 1
  s_bfe_u32 s69, s68, 0x30002
  s_lshr_b32 s70, s68, 5
  s_and_b32 s10, s68, 3
  s_lshl2_add_u32 s70, s70, s10
  s_lshl_b32 s23, s69, 7
  s_add_u32 s23, s23, s28
  s_lshl_b32 s69, s69, 14
  s_add_u32 s69, s69, s27
  s_and_b32 s10, s70, 3
  s_lshl_b32 s11, s10, 5
  s_add_u32 s23, s23, s11
  s_lshl_b32 s10, s10, 12
  s_add_u32 s69, s69, s10
  s_lshr_b32 s70, s70, 2
  s_lshl_b32 s11, s70, 11
  s_add_u32 s23, s23, s11
  s_lshl_b32 s70, s70, 19
  s_add_u32 s69, s69, s70
  s_cmp_lt_u32 s68, 128
  s_cselect_b32 s69, s69, 0x7ff00000
  s_cselect_b32 s62, s23, 0x7ff00000
  s_cselect_b32 s76, s24, 0x0c0c0c0c
  s_cselect_b32 s77, s25, 0x0c0c0c0c
  s_add_u32 s70, s69, 2048
  v_mov_b32 v50, 1
  s_mov_b64 exec, 1
  buffer_atomic_add v50, v17, s[88:91], s26 offen sc0 sc1
  s_mov_b64 exec, -1
  buffer_load_dword v22, v16, s[88:91], s62 offen sc1
  buffer_load_dwordx4 v[160:163], v1, s[48:51], s69 offen nt
  buffer_load_dwordx4 v[164:167], v1, s[48:51], s69 offen offset:256 nt
  buffer_load_dwordx4 v[168:171], v1, s[48:51], s70 offen nt
  buffer_load_dwordx4 v[172:175], v1, s[48:51], s70 offen offset:256 nt
  v_perm_b32 v89, v79, v79, s25
  v_and_b32 v44, v4, v89
  v_and_b32 v45, v5, v89
  v_and_b32 v46, v6, v89
  v_and_b32 v47, v7, v89
  s_nop 0
  s_waitcnt vmcnt(18)
  v_mfma_f32_16x16x32_bf16 v[32:35], v[44:47], v[120:123], v[32:35]
  v_mfma_f32_16x16x32_bf16 v[36:39], v[44:47], v[124:127], v[36:39]
  s_waitcnt lgkmcnt(0)
  v_mov_b32 v13, v30
  s_nop 5
  v_mul_f32 v32, v32, v28
  v_mul_f32 v33, v33, v28
  v_mul_f32 v34, v34, v28
  v_mul_f32 v35, v35, v28
  v_mul_f32 v36, v36, v28
  v_mul_f32 v37, v37, v28
  v_mul_f32 v38, v38, v28
  v_mul_f32 v39, v39, v28
  s_cmp_ge_u32 s71, 128
  s_cbranch_scc1 L_vdone
L_dloop:
  s_waitcnt vmcnt(11)
  v_readfirstlane_b32 s68, v49
  s_nop 3
  s_add_u32 s68, s68, 1
  s_cmp_ge_u32 s68, 128
  s_cbranch_scc1 L_drain0
  s_bfe_u32 s69, s68, 0x30002
  s_lshr_b32 s70, s68, 5
  s_and_b32 s10, s68, 3
  s_lshl2_add_u32 s70, s70, s10
  s_lshl_b32 s23, s69, 7
  s_add_u32 s23, s23, s28
  s_lshl_b32 s69, s69, 14
  s_add_u32 s69, s69, s27
  s_and_b32 s10, s70, 3
  s_lshl_b32 s11, s10, 5
  s_add_u32 s23, s23, s11
  s_lshl_b32 s10, s10, 12
  s_add_u32 s69, s69, s10
  s_lshr_b32 s70, s70, 2
  s_lshl_b32 s11, s70, 11
  s_add_u32 s23, s23, s11
  s_lshl_b32 s70, s70, 19
  s_add_u32 s69, s69, s70
  s_mov_b32 s63, s23
  s_mov_b32 s78, s24
  s_mov_b32 s79, s25
  s_add_u32 s70, s69, 2048
  v_mov_b32 v51, 1
  s_mov_b64 exec, 1
  buffer_atomic_add v51, v17, s[88:91], s26 offen sc0 sc1
  s_mov_b64 exec, -1
  buffer_load_dword v23, v16, s[88:91], s63 offen sc1
  buffer_load_dwordx4 v[176:179], v1, s[48:51], s69 offen nt
  buffer_load_dwordx4 v[180:183], v1, s[48:51], s69 offen offset:256 nt
  buffer_load_dwordx4 v[184:187], v1, s[48:51], s70 offen nt
  buffer_load_dwordx4 v[188:191], v1, s[48:51], s70 offen offset:256 nt
  v_cmp_eq_u32 vcc, -1, v20
  s_cbranch_vccz L_so_88
  s_mov_b32 s15, 1048576
  L_sr_87:
  buffer_load_dword v20, v16, s[88:91], s60 offen sc1
  s_waitcnt vmcnt(0)
  v_cmp_eq_u32 vcc, -1, v20
  s_cbranch_vccz L_so_88
  s_sub_u32 s15, s15, 1
  s_cmp_lg_u32 s15, 0
  s_cbranch_scc1 L_sr_87
  L_so_88:
  v_lshlrev_b32 v90, 16, v20
  v_and_b32 v91, 0xffff0000, v20
  v_fma_f32 v90, v90, s14, v13
  v_fma_f32 v91, v91, s14, v13
  v_exp_f32 v90, v90
  v_exp_f32 v91, v91
  s_nop 0
  v_cvt_pk_bf16_f32 v90, v90, v91
  v_perm_b32 v88, v90, v90, s72
  v_perm_b32 v89, v90, v90, s73
  v_and_b32 v40, v4, v88
  v_and_b32 v41, v5, v88
  v_and_b32 v42, v6, v88
  v_and_b32 v43, v7, v88
  v_and_b32 v44, v4, v89
  v_and_b32 v45, v5, v89
  v_and_b32 v46, v6, v89
  v_and_b32 v47, v7, v89
  v_mfma_f32_16x16x32_bf16 v[32:35], v[40:43], v[128:131], v[32:35]
  v_mfma_f32_16x16x32_bf16 v[36:39], v[40:43], v[132:135], v[36:39]
  v_mfma_f32_16x16x32_bf16 v[32:35], v[44:47], v[136:139], v[32:35]
  v_mfma_f32_16x16x32_bf16 v[36:39], v[44:47], v[140:143], v[36:39]
  s_waitcnt vmcnt(11)
  v_readfirstlane_b32 s68, v50
  s_nop 3
  s_add_u32 s68, s68, 1
  s_cmp_ge_u32 s68, 128
  s_cbranch_scc1 L_drain1
  s_bfe_u32 s69, s68, 0x30002
  s_lshr_b32 s70, s68, 5
  s_and_b32 s10, s68, 3
  s_lshl2_add_u32 s70, s70, s10
  s_lshl_b32 s23, s69, 7
  s_add_u32 s23, s23, s28
  s_lshl_b32 s69, s69, 14
  s_add_u32 s69, s69, s27
  s_and_b32 s10, s70, 3
  s_lshl_b32 s11, s10, 5
  s_add_u32 s23, s23, s11
  s_lshl_b32 s10, s10, 12
  s_add_u32 s69, s69, s10
  s_lshr_b32 s70, s70, 2
  s_lshl_b32 s11, s70, 11
  s_add_u32 s23, s23, s11
  s_lshl_b32 s70, s70, 19
  s_add_u32 s69, s69, s70
  s_mov_b32 s60, s23
  s_mov_b32 s72, s24
  s_mov_b32 s73, s25
  s_add_u32 s70, s69, 2048
  v_mov_b32 v48, 1
  s_mov_b64 exec, 1
  buffer_atomic_add v48, v17, s[88:91], s26 offen sc0 sc1
  s_mov_b64 exec, -1
  buffer_load_dword v20, v16, s[88:91], s60 offen sc1
  buffer_load_dwordx4 v[128:131], v1, s[48:51], s69 offen nt
  buffer_load_dwordx4 v[132:135], v1, s[48:51], s69 offen offset:256 nt
  buffer_load_dwordx4 v[136:139], v1, s[48:51], s70 offen nt
  buffer_load_dwordx4 v[140:143], v1, s[48:51], s70 offen offset:256 nt
  v_cmp_eq_u32 vcc, -1, v21
  s_cbranch_vccz L_so_90
  s_mov_b32 s15, 1048576
  L_sr_89:
  buffer_load_dword v21, v16, s[88:91], s61 offen sc1
  s_waitcnt vmcnt(0)
  v_cmp_eq_u32 vcc, -1, v21
  s_cbranch_vccz L_so_90
  s_sub_u32 s15, s15, 1
  s_cmp_lg_u32 s15, 0
  s_cbranch_scc1 L_sr_89
  L_so_90:
  v_lshlrev_b32 v90, 16, v21
  v_and_b32 v91, 0xffff0000, v21
  v_fma_f32 v90, v90, s14, v13
  v_fma_f32 v91, v91, s14, v13
  v_exp_f32 v90, v90
  v_exp_f32 v91, v91
  s_nop 0
  v_cvt_pk_bf16_f32 v90, v90, v91
  v_perm_b32 v88, v90, v90, s74
  v_perm_b32 v89, v90, v90, s75
  v_and_b32 v40, v4, v88
  v_and_b32 v41, v5, v88
  v_and_b32 v42, v6, v88
  v_and_b32 v43, v7, v88
  v_and_b32 v44, v4, v89
  v_and_b32 v45, v5, v89
  v_and_b32 v46, v6, v89
  v_and_b32 v47, v7, v89
  v_mfma_f32_16x16x32_bf16 v[32:35], v[40:43], v[144:147], v[32:35]
  v_mfma_f32_16x16x32_bf16 v[36:39], v[40:43], v[148:151], v[36:39]
  v_mfma_f32_16x16x32_bf16 v[32:35], v[44:47], v[152:155], v[32:35]
  v_mfma_f32_16x16x32_bf16 v[36:39], v[44:47], v[156:159], v[36:39]
  s_waitcnt vmcnt(11)
  v_readfirstlane_b32 s68, v51
  s_nop 3
  s_add_u32 s68, s68, 1
  s_cmp_ge_u32 s68, 128
  s_cbranch_scc1 L_drain2
  s_bfe_u32 s69, s68, 0x30002
  s_lshr_b32 s70, s68, 5
  s_and_b32 s10, s68, 3
  s_lshl2_add_u32 s70, s70, s10
  s_lshl_b32 s23, s69, 7
  s_add_u32 s23, s23, s28
  s_lshl_b32 s69, s69, 14
  s_add_u32 s69, s69, s27
  s_and_b32 s10, s70, 3
  s_lshl_b32 s11, s10, 5
  s_add_u32 s23, s23, s11
  s_lshl_b32 s10, s10, 12
  s_add_u32 s69, s69, s10
  s_lshr_b32 s70, s70, 2
  s_lshl_b32 s11, s70, 11
  s_add_u32 s23, s23, s11
  s_lshl_b32 s70, s70, 19
  s_add_u32 s69, s69, s70
  s_mov_b32 s61, s23
  s_mov_b32 s74, s24
  s_mov_b32 s75, s25
  s_add_u32 s70, s69, 2048
  v_mov_b32 v49, 1
  s_mov_b64 exec, 1
  buffer_atomic_add v49, v17, s[88:91], s26 offen sc0 sc1
  s_mov_b64 exec, -1
  buffer_load_dword v21, v16, s[88:91], s61 offen sc1
  buffer_load_dwordx4 v[144:147], v1, s[48:51], s69 offen nt
  buffer_load_dwordx4 v[148:151], v1, s[48:51], s69 offen offset:256 nt
  buffer_load_dwordx4 v[152:155], v1, s[48:51], s70 offen nt
  buffer_load_dwordx4 v[156:159], v1, s[48:51], s70 offen offset:256 nt
  v_cmp_eq_u32 vcc, -1, v22
  s_cbranch_vccz L_so_92
  s_mov_b32 s15, 1048576
  L_sr_91:
  buffer_load_dword v22, v16, s[88:91], s62 offen sc1
  s_waitcnt vmcnt(0)
  v_cmp_eq_u32 vcc, -1, v22
  s_cbranch_vccz L_so_92
  s_sub_u32 s15, s15, 1
  s_cmp_lg_u32 s15, 0
  s_cbranch_scc1 L_sr_91
  L_so_92:
  v_lshlrev_b32 v90, 16, v22
  v_and_b32 v91, 0xffff0000, v22
  v_fma_f32 v90, v90, s14, v13
  v_fma_f32 v91, v91, s14, v13
  v_exp_f32 v90, v90
  v_exp_f32 v91, v91
  s_nop 0
  v_cvt_pk_bf16_f32 v90, v90, v91
  v_perm_b32 v88, v90, v90, s76
  v_perm_b32 v89, v90, v90, s77
  v_and_b32 v40, v4, v88
  v_and_b32 v41, v5, v88
  v_and_b32 v42, v6, v88
  v_and_b32 v43, v7, v88
  v_and_b32 v44, v4, v89
  v_and_b32 v45, v5, v89
  v_and_b32 v46, v6, v89
  v_and_b32 v47, v7, v89
  v_mfma_f32_16x16x32_bf16 v[32:35], v[40:43], v[160:163], v[32:35]
  v_mfma_f32_16x16x32_bf16 v[36:39], v[40:43], v[164:167], v[36:39]
  v_mfma_f32_16x16x32_bf16 v[32:35], v[44:47], v[168:171], v[32:35]
  v_mfma_f32_16x16x32_bf16 v[36:39], v[44:47], v[172:175], v[36:39]
  s_waitcnt vmcnt(11)
  v_readfirstlane_b32 s68, v48
  s_nop 3
  s_add_u32 s68, s68, 1
  s_cmp_ge_u32 s68, 128
  s_cbranch_scc1 L_drain3
  s_bfe_u32 s69, s68, 0x30002
  s_lshr_b32 s70, s68, 5
  s_and_b32 s10, s68, 3
  s_lshl2_add_u32 s70, s70, s10
  s_lshl_b32 s23, s69, 7
  s_add_u32 s23, s23, s28
  s_lshl_b32 s69, s69, 14
  s_add_u32 s69, s69, s27
  s_and_b32 s10, s70, 3
  s_lshl_b32 s11, s10, 5
  s_add_u32 s23, s23, s11
  s_lshl_b32 s10, s10, 12
  s_add_u32 s69, s69, s10
  s_lshr_b32 s70, s70, 2
  s_lshl_b32 s11, s70, 11
  s_add_u32 s23, s23, s11
  s_lshl_b32 s70, s70, 19
  s_add_u32 s69, s69, s70
  s_mov_b32 s62, s23
  s_mov_b32 s76, s24
  s_mov_b32 s77, s25
  s_add_u32 s70, s69, 2048
  v_mov_b32 v50, 1
  s_mov_b64 exec, 1
  buffer_atomic_add v50, v17, s[88:91], s26 offen sc0 sc1
  s_mov_b64 exec, -1
  buffer_load_dword v22, v16, s[88:91], s62 offen sc1
  buffer_load_dwordx4 v[160:163], v1, s[48:51], s69 offen nt
  buffer_load_dwordx4 v[164:167], v1, s[48:51], s69 offen offset:256 nt
  buffer_load_dwordx4 v[168:171], v1, s[48:51], s70 offen nt
  buffer_load_dwordx4 v[172:175], v1, s[48:51], s70 offen offset:256 nt
  v_cmp_eq_u32 vcc, -1, v23
  s_cbranch_vccz L_so_94
  s_mov_b32 s15, 1048576
  L_sr_93:
  buffer_load_dword v23, v16, s[88:91], s63 offen sc1
  s_waitcnt vmcnt(0)
  v_cmp_eq_u32 vcc, -1, v23
  s_cbranch_vccz L_so_94
  s_sub_u32 s15, s15, 1
  s_cmp_lg_u32 s15, 0
  s_cbranch_scc1 L_sr_93
  L_so_94:
  v_lshlrev_b32 v90, 16, v23
  v_and_b32 v91, 0xffff0000, v23
  v_fma_f32 v90, v90, s14, v13
  v_fma_f32 v91, v91, s14, v13
  v_exp_f32 v90, v90
  v_exp_f32 v91, v91
  s_nop 0
  v_cvt_pk_bf16_f32 v90, v90, v91
  v_perm_b32 v88, v90, v90, s78
  v_perm_b32 v89, v90, v90, s79
  v_and_b32 v40, v4, v88
  v_and_b32 v41, v5, v88
  v_and_b32 v42, v6, v88
  v_and_b32 v43, v7, v88
  v_and_b32 v44, v4, v89
  v_and_b32 v45, v5, v89
  v_and_b32 v46, v6, v89
  v_and_b32 v47, v7, v89
  v_mfma_f32_16x16x32_bf16 v[32:35], v[40:43], v[176:179], v[32:35]
  v_mfma_f32_16x16x32_bf16 v[36:39], v[40:43], v[180:183], v[36:39]
  v_mfma_f32_16x16x32_bf16 v[32:35], v[44:47], v[184:187], v[32:35]
  v_mfma_f32_16x16x32_bf16 v[36:39], v[44:47], v[188:191], v[36:39]
  s_branch L_dloop
L_drain0:
  v_cmp_eq_u32 vcc, -1, v20
  s_cbranch_vccz L_so_96
  s_mov_b32 s15, 1048576
  L_sr_95:
  buffer_load_dword v20, v16, s[88:91], s60 offen sc1
  s_waitcnt vmcnt(0)
  v_cmp_eq_u32 vcc, -1, v20
  s_cbranch_vccz L_so_96
  s_sub_u32 s15, s15, 1
  s_cmp_lg_u32 s15, 0
  s_cbranch_scc1 L_sr_95
  L_so_96:
  v_lshlrev_b32 v90, 16, v20
  v_and_b32 v91, 0xffff0000, v20
  v_fma_f32 v90, v90, s14, v13
  v_fma_f32 v91, v91, s14, v13
  v_exp_f32 v90, v90
  v_exp_f32 v91, v91
  s_nop 0
  v_cvt_pk_bf16_f32 v90, v90, v91
  v_perm_b32 v88, v90, v90, s72
  v_perm_b32 v89, v90, v90, s73
  v_and_b32 v40, v4, v88
  v_and_b32 v41, v5, v88
  v_and_b32 v42, v6, v88
  v_and_b32 v43, v7, v88
  v_and_b32 v44, v4, v89
  v_and_b32 v45, v5, v89
  v_and_b32 v46, v6, v89
  v_and_b32 v47, v7, v89
  v_mfma_f32_16x16x32_bf16 v[32:35], v[40:43], v[128:131], v[32:35]
  v_mfma_f32_16x16x32_bf16 v[36:39], v[40:43], v[132:135], v[36:39]
  v_mfma_f32_16x16x32_bf16 v[32:35], v[44:47], v[136:139], v[32:35]
  v_mfma_f32_16x16x32_bf16 v[36:39], v[44:47], v[140:143], v[36:39]
  s_waitcnt vmcnt(6)
  v_cmp_eq_u32 vcc, -1, v21
  s_cbranch_vccz L_so_98
  s_mov_b32 s15, 1048576
  L_sr_97:
  buffer_load_dword v21, v16, s[88:91], s61 offen sc1
  s_waitcnt vmcnt(0)
  v_cmp_eq_u32 vcc, -1, v21
  s_cbranch_vccz L_so_98
  s_sub_u32 s15, s15, 1
  s_cmp_lg_u32 s15, 0
  s_cbranch_scc1 L_sr_97
  L_so_98:
  v_lshlrev_b32 v90, 16, v21
  v_and_b32 v91, 0xffff0000, v21
  v_fma_f32 v90, v90, s14, v13
  v_fma_f32 v91, v91, s14, v13
  v_exp_f32 v90, v90
  v_exp_f32 v91, v91
  s_nop 0
  v_cvt_pk_bf16_f32 v90, v90, v91
  v_perm_b32 v88, v90, v90, s74
  v_perm_b32 v89, v90, v90, s75
  v_and_b32 v40, v4, v88
  v_and_b32 v41, v5, v88
  v_and_b32 v42, v6, v88
  v_and_b32 v43, v7, v88
  v_and_b32 v44, v4, v89
  v_and_b32 v45, v5, v89
  v_and_b32 v46, v6, v89
  v_and_b32 v47, v7, v89
  v_mfma_f32_16x16x32_bf16 v[32:35], v[40:43], v[144:147], v[32:35]
  v_mfma_f32_16x16x32_bf16 v[36:39], v[40:43], v[148:151], v[36:39]
  v_mfma_f32_16x16x32_bf16 v[32:35], v[44:47], v[152:155], v[32:35]
  v_mfma_f32_16x16x32_bf16 v[36:39], v[44:47], v[156:159], v[36:39]
  s_waitcnt vmcnt(0)
  v_cmp_eq_u32 vcc, -1, v22
  s_cbranch_vccz L_so_100
  s_mov_b32 s15, 1048576
  L_sr_99:
  buffer_load_dword v22, v16, s[88:91], s62 offen sc1
  s_waitcnt vmcnt(0)
  v_cmp_eq_u32 vcc, -1, v22
  s_cbranch_vccz L_so_100
  s_sub_u32 s15, s15, 1
  s_cmp_lg_u32 s15, 0
  s_cbranch_scc1 L_sr_99
  L_so_100:
  v_lshlrev_b32 v90, 16, v22
  v_and_b32 v91, 0xffff0000, v22
  v_fma_f32 v90, v90, s14, v13
  v_fma_f32 v91, v91, s14, v13
  v_exp_f32 v90, v90
  v_exp_f32 v91, v91
  s_nop 0
  v_cvt_pk_bf16_f32 v90, v90, v91
  v_perm_b32 v88, v90, v90, s76
  v_perm_b32 v89, v90, v90, s77
  v_and_b32 v40, v4, v88
  v_and_b32 v41, v5, v88
  v_and_b32 v42, v6, v88
  v_and_b32 v43, v7, v88
  v_and_b32 v44, v4, v89
  v_and_b32 v45, v5, v89
  v_and_b32 v46, v6, v89
  v_and_b32 v47, v7, v89
  v_mfma_f32_16x16x32_bf16 v[32:35], v[40:43], v[160:163], v[32:35]
  v_mfma_f32_16x16x32_bf16 v[36:39], v[40:43], v[164:167], v[36:39]
  v_mfma_f32_16x16x32_bf16 v[32:35], v[44:47], v[168:171], v[32:35]
  v_mfma_f32_16x16x32_bf16 v[36:39], v[44:47], v[172:175], v[36:39]
  s_branch L_vdone
L_drain1:
  v_cmp_eq_u32 vcc, -1, v21
  s_cbranch_vccz L_so_102
  s_mov_b32 s15, 1048576
  L_sr_101:
  buffer_load_dword v21, v16, s[88:91], s61 offen sc1
  s_waitcnt vmcnt(0)
  v_cmp_eq_u32 vcc, -1, v21
  s_cbranch_vccz L_so_102
  s_sub_u32 s15, s15, 1
  s_cmp_lg_u32 s15, 0
  s_cbranch_scc1 L_sr_101
  L_so_102:
  v_lshlrev_b32 v90, 16, v21
  v_and_b32 v91, 0xffff0000, v21
  v_fma_f32 v90, v90, s14, v13
  v_fma_f32 v91, v91, s14, v13
  v_exp_f32 v90, v90
  v_exp_f32 v91, v91
  s_nop 0
  v_cvt_pk_bf16_f32 v90, v90, v91
  v_perm_b32 v88, v90, v90, s74
  v_perm_b32 v89, v90, v90, s75
  v_and_b32 v40, v4, v88
  v_and_b32 v41, v5, v88
  v_and_b32 v42, v6, v88
  v_and_b32 v43, v7, v88
  v_and_b32 v44, v4, v89
  v_and_b32 v45, v5, v89
  v_and_b32 v46, v6, v89
  v_and_b32 v47, v7, v89
  v_mfma_f32_16x16x32_bf16 v[32:35], v[40:43], v[144:147], v[32:35]
  v_mfma_f32_16x16x32_bf16 v[36:39], v[40:43], v[148:151], v[36:39]
  v_mfma_f32_16x16x32_bf16 v[32:35], v[44:47], v[152:155], v[32:35]
  v_mfma_f32_16x16x32_bf16 v[36:39], v[44:47], v[156:159], v[36:39]
  s_waitcnt vmcnt(6)
  v_cmp_eq_u32 vcc, -1, v22
  s_cbranch_vccz L_so_104
  s_mov_b32 s15, 1048576
  L_sr_103:
  buffer_load_dword v22, v16, s[88:91], s62 offen sc1
  s_waitcnt vmcnt(0)
  v_cmp_eq_u32 vcc, -1, v22
  s_cbranch_vccz L_so_104
  s_sub_u32 s15, s15, 1
  s_cmp_lg_u32 s15, 0
  s_cbranch_scc1 L_sr_103
  L_so_104:
  v_lshlrev_b32 v90, 16, v22
  v_and_b32 v91, 0xffff0000, v22
  v_fma_f32 v90, v90, s14, v13
  v_fma_f32 v91, v91, s14, v13
  v_exp_f32 v90, v90
  v_exp_f32 v91, v91
  s_nop 0
  v_cvt_pk_bf16_f32 v90, v90, v91
  v_perm_b32 v88, v90, v90, s76
  v_perm_b32 v89, v90, v90, s77
  v_and_b32 v40, v4, v88
  v_and_b32 v41, v5, v88
  v_and_b32 v42, v6, v88
  v_and_b32 v43, v7, v88
  v_and_b32 v44, v4, v89
  v_and_b32 v45, v5, v89
  v_and_b32 v46, v6, v89
  v_and_b32 v47, v7, v89
  v_mfma_f32_16x16x32_bf16 v[32:35], v[40:43], v[160:163], v[32:35]
  v_mfma_f32_16x16x32_bf16 v[36:39], v[40:43], v[164:167], v[36:39]
  v_mfma_f32_16x16x32_bf16 v[32:35], v[44:47], v[168:171], v[32:35]
  v_mfma_f32_16x16x32_bf16 v[36:39], v[44:47], v[172:175], v[36:39]
  s_waitcnt vmcnt(0)
  v_cmp_eq_u32 vcc, -1, v23
  s_cbranch_vccz L_so_106
  s_mov_b32 s15, 1048576
  L_sr_105:
  buffer_load_dword v23, v16, s[88:91], s63 offen sc1
  s_waitcnt vmcnt(0)
  v_cmp_eq_u32 vcc, -1, v23
  s_cbranch_vccz L_so_106
  s_sub_u32 s15, s15, 1
  s_cmp_lg_u32 s15, 0
  s_cbranch_scc1 L_sr_105
  L_so_106:
  v_lshlrev_b32 v90, 16, v23
  v_and_b32 v91, 0xffff0000, v23
  v_fma_f32 v90, v90, s14, v13
  v_fma_f32 v91, v91, s14, v13
  v_exp_f32 v90, v90
  v_exp_f32 v91, v91
  s_nop 0
  v_cvt_pk_bf16_f32 v90, v90, v91
  v_perm_b32 v88, v90, v90, s78
  v_perm_b32 v89, v90, v90, s79
  v_and_b32 v40, v4, v88
  v_and_b32 v41, v5, v88
  v_and_b32 v42, v6, v88
  v_and_b32 v43, v7, v88
  v_and_b32 v44, v4, v89
  v_and_b32 v45, v5, v89
  v_and_b32 v46, v6, v89
  v_and_b32 v47, v7, v89
  v_mfma_f32_16x16x32_bf16 v[32:35], v[40:43], v[176:179], v[32:35]
  v_mfma_f32_16x16x32_bf16 v[36:39], v[40:43], v[180:183], v[36:39]
  v_mfma_f32_16x16x32_bf16 v[32:35], v[44:47], v[184:187], v[32:35]
  v_mfma_f32_16x16x32_bf16 v[36:39], v[44:47], v[188:191], v[36:39]
  s_branch L_vdone
L_drain2:
  v_cmp_eq_u32 vcc, -1, v22
  s_cbranch_vccz L_so_108
  s_mov_b32 s15, 1048576
  L_sr_107:
  buffer_load_dword v22, v16, s[88:91], s62 offen sc1
  s_waitcnt vmcnt(0)
  v_cmp_eq_u32 vcc, -1, v22
  s_cbranch_vccz L_so_108
  s_sub_u32 s15, s15, 1
  s_cmp_lg_u32 s15, 0
  s_cbranch_scc1 L_sr_107
  L_so_108:
  v_lshlrev_b32 v90, 16, v22
  v_and_b32 v91, 0xffff0000, v22
  v_fma_f32 v90, v90, s14, v13
  v_fma_f32 v91, v91, s14, v13
  v_exp_f32 v90, v90
  v_exp_f32 v91, v91
  s_nop 0
  v_cvt_pk_bf16_f32 v90, v90, v91
  v_perm_b32 v88, v90, v90, s76
  v_perm_b32 v89, v90, v90, s77
  v_and_b32 v40, v4, v88
  v_and_b32 v41, v5, v88
  v_and_b32 v42, v6, v88
  v_and_b32 v43, v7, v88
  v_and_b32 v44, v4, v89
  v_and_b32 v45, v5, v89
  v_and_b32 v46, v6, v89
  v_and_b32 v47, v7, v89
  v_mfma_f32_16x16x32_bf16 v[32:35], v[40:43], v[160:163], v[32:35]
  v_mfma_f32_16x16x32_bf16 v[36:39], v[40:43], v[164:167], v[36:39]
  v_mfma_f32_16x16x32_bf16 v[32:35], v[44:47], v[168:171], v[32:35]
  v_mfma_f32_16x16x32_bf16 v[36:39], v[44:47], v[172:175], v[36:39]
  s_waitcnt vmcnt(6)
  v_cmp_eq_u32 vcc, -1, v23
  s_cbranch_vccz L_so_110
  s_mov_b32 s15, 1048576
  L_sr_109:
  buffer_load_dword v23, v16, s[88:91], s63 offen sc1
  s_waitcnt vmcnt(0)
  v_cmp_eq_u32 vcc, -1, v23
  s_cbranch_vccz L_so_110
  s_sub_u32 s15, s15, 1
  s_cmp_lg_u32 s15, 0
  s_cbranch_scc1 L_sr_109
  L_so_110:
  v_lshlrev_b32 v90, 16, v23
  v_and_b32 v91, 0xffff0000, v23
  v_fma_f32 v90, v90, s14, v13
  v_fma_f32 v91, v91, s14, v13
  v_exp_f32 v90, v90
  v_exp_f32 v91, v91
  s_nop 0
  v_cvt_pk_bf16_f32 v90, v90, v91
  v_perm_b32 v88, v90, v90, s78
  v_perm_b32 v89, v90, v90, s79
  v_and_b32 v40, v4, v88
  v_and_b32 v41, v5, v88
  v_and_b32 v42, v6, v88
  v_and_b32 v43, v7, v88
  v_and_b32 v44, v4, v89
  v_and_b32 v45, v5, v89
  v_and_b32 v46, v6, v89
  v_and_b32 v47, v7, v89
  v_mfma_f32_16x16x32_bf16 v[32:35], v[40:43], v[176:179], v[32:35]
  v_mfma_f32_16x16x32_bf16 v[36:39], v[40:43], v[180:183], v[36:39]
  v_mfma_f32_16x16x32_bf16 v[32:35], v[44:47], v[184:187], v[32:35]
  v_mfma_f32_16x16x32_bf16 v[36:39], v[44:47], v[188:191], v[36:39]
  s_waitcnt vmcnt(0)
  v_cmp_eq_u32 vcc, -1, v20
  s_cbranch_vccz L_so_112
  s_mov_b32 s15, 1048576
  L_sr_111:
  buffer_load_dword v20, v16, s[88:91], s60 offen sc1
  s_waitcnt vmcnt(0)
  v_cmp_eq_u32 vcc, -1, v20
  s_cbranch_vccz L_so_112
  s_sub_u32 s15, s15, 1
  s_cmp_lg_u32 s15, 0
  s_cbranch_scc1 L_sr_111
  L_so_112:
  v_lshlrev_b32 v90, 16, v20
  v_and_b32 v91, 0xffff0000, v20
  v_fma_f32 v90, v90, s14, v13
  v_fma_f32 v91, v91, s14, v13
  v_exp_f32 v90, v90
  v_exp_f32 v91, v91
  s_nop 0
  v_cvt_pk_bf16_f32 v90, v90, v91
  v_perm_b32 v88, v90, v90, s72
  v_perm_b32 v89, v90, v90, s73
  v_and_b32 v40, v4, v88
  v_and_b32 v41, v5, v88
  v_and_b32 v42, v6, v88
  v_and_b32 v43, v7, v88
  v_and_b32 v44, v4, v89
  v_and_b32 v45, v5, v89
  v_and_b32 v46, v6, v89
  v_and_b32 v47, v7, v89
  v_mfma_f32_16x16x32_bf16 v[32:35], v[40:43], v[128:131], v[32:35]
  v_mfma_f32_16x16x32_bf16 v[36:39], v[40:43], v[132:135], v[36:39]
  v_mfma_f32_16x16x32_bf16 v[32:35], v[44:47], v[136:139], v[32:35]
  v_mfma_f32_16x16x32_bf16 v[36:39], v[44:47], v[140:143], v[36:39]
  s_branch L_vdone
L_drain3:
  v_cmp_eq_u32 vcc, -1, v23
  s_cbranch_vccz L_so_114
  s_mov_b32 s15, 1048576
  L_sr_113:
  buffer_load_dword v23, v16, s[88:91], s63 offen sc1
  s_waitcnt vmcnt(0)
  v_cmp_eq_u32 vcc, -1, v23
  s_cbranch_vccz L_so_114
  s_sub_u32 s15, s15, 1
  s_cmp_lg_u32 s15, 0
  s_cbranch_scc1 L_sr_113
  L_so_114:
  v_lshlrev_b32 v90, 16, v23
  v_and_b32 v91, 0xffff0000, v23
  v_fma_f32 v90, v90, s14, v13
  v_fma_f32 v91, v91, s14, v13
  v_exp_f32 v90, v90
  v_exp_f32 v91, v91
  s_nop 0
  v_cvt_pk_bf16_f32 v90, v90, v91
  v_perm_b32 v88, v90, v90, s78
  v_perm_b32 v89, v90, v90, s79
  v_and_b32 v40, v4, v88
  v_and_b32 v41, v5, v88
  v_and_b32 v42, v6, v88
  v_and_b32 v43, v7, v88
  v_and_b32 v44, v4, v89
  v_and_b32 v45, v5, v89
  v_and_b32 v46, v6, v89
  v_and_b32 v47, v7, v89
  v_mfma_f32_16x16x32_bf16 v[32:35], v[40:43], v[176:179], v[32:35]
  v_mfma_f32_16x16x32_bf16 v[36:39], v[40:43], v[180:183], v[36:39]
  v_mfma_f32_16x16x32_bf16 v[32:35], v[44:47], v[184:187], v[32:35]
  v_mfma_f32_16x16x32_bf16 v[36:39], v[44:47], v[188:191], v[36:39]
  s_waitcnt vmcnt(6)
  v_cmp_eq_u32 vcc, -1, v20
  s_cbranch_vccz L_so_116
  s_mov_b32 s15, 1048576
  L_sr_115:
  buffer_load_dword v20, v16, s[88:91], s60 offen sc1
  s_waitcnt vmcnt(0)
  v_cmp_eq_u32 vcc, -1, v20
  s_cbranch_vccz L_so_116
  s_sub_u32 s15, s15, 1
  s_cmp_lg_u32 s15, 0
  s_cbranch_scc1 L_sr_115
  L_so_116:
  v_lshlrev_b32 v90, 16, v20
  v_and_b32 v91, 0xffff0000, v20
  v_fma_f32 v90, v90, s14, v13
  v_fma_f32 v91, v91, s14, v13
  v_exp_f32 v90, v90
  v_exp_f32 v91, v91
  s_nop 0
  v_cvt_pk_bf16_f32 v90, v90, v91
  v_perm_b32 v88, v90, v90, s72
  v_perm_b32 v89, v90, v90, s73
  v_and_b32 v40, v4, v88
  v_and_b32 v41, v5, v88
  v_and_b32 v42, v6, v88
  v_and_b32 v43, v7, v88
  v_and_b32 v44, v4, v89
  v_and_b32 v45, v5, v89
  v_and_b32 v46, v6, v89
  v_and_b32 v47, v7, v89
  v_mfma_f32_16x16x32_bf16 v[32:35], v[40:43], v[128:131], v[32:35]
  v_mfma_f32_16x16x32_bf16 v[36:39], v[40:43], v[132:135], v[36:39]
  v_mfma_f32_16x16x32_bf16 v[32:35], v[44:47], v[136:139], v[32:35]
  v_mfma_f32_16x16x32_bf16 v[36:39], v[44:47], v[140:143], v[36:39]
  s_waitcnt vmcnt(0)
  v_cmp_eq_u32 vcc, -1, v21
  s_cbranch_vccz L_so_118
  s_mov_b32 s15, 1048576
  L_sr_117:
  buffer_load_dword v21, v16, s[88:91], s61 offen sc1
  s_waitcnt vmcnt(0)
  v_cmp_eq_u32 vcc, -1, v21
  s_cbranch_vccz L_so_118
  s_sub_u32 s15, s15, 1
  s_cmp_lg_u32 s15, 0
  s_cbranch_scc1 L_sr_117
  L_so_118:
  v_lshlrev_b32 v90, 16, v21
  v_and_b32 v91, 0xffff0000, v21
  v_fma_f32 v90, v90, s14, v13
  v_fma_f32 v91, v91, s14, v13
  v_exp_f32 v90, v90
  v_exp_f32 v91, v91
  s_nop 0
  v_cvt_pk_bf16_f32 v90, v90, v91
  v_perm_b32 v88, v90, v90, s74
  v_perm_b32 v89, v90, v90, s75
  v_and_b32 v40, v4, v88
  v_and_b32 v41, v5, v88
  v_and_b32 v42, v6, v88
  v_and_b32 v43, v7, v88
  v_and_b32 v44, v4, v89
  v_and_b32 v45, v5, v89
  v_and_b32 v46, v6, v89
  v_and_b32 v47, v7, v89
  v_mfma_f32_16x16x32_bf16 v[32:35], v[40:43], v[144:147], v[32:35]
  v_mfma_f32_16x16x32_bf16 v[36:39], v[40:43], v[148:151], v[36:39]
  v_mfma_f32_16x16x32_bf16 v[32:35], v[44:47], v[152:155], v[32:35]
  v_mfma_f32_16x16x32_bf16 v[36:39], v[44:47], v[156:159], v[36:39]
L_vdone:
  s_nop 7
  ds_write_b128 v10, v[32:35]
  ds_write_b128 v10, v[36:39] offset:512
  s_waitcnt lgkmcnt(0)
  s_barrier
  s_waitcnt vmcnt(0)
  s_branch L_t3pre
L_helper:
  s_lshl_b32 s10, s3, 6
  v_add_u32 v1, s10, v0
  s_lshl_b32 s11, s8, 3
  s_add_u32 s11, s11, s5
  s_waitcnt lgkmcnt(0)
  s_mov_b32 s88, s40
  s_mov_b32 s89, s41
  s_mov_b32 s90, 0x800000
  s_mov_b32 s91, 0x20000
  s_mov_b32 s56, s22
  s_mov_b32 s57, s23
  s_mov_b32 s58, 0x380000
  s_mov_b32 s59, 0x20000
  s_mov_b32 s84, s38
  s_mov_b32 s85, s39
  s_mov_b32 s86, 0x100
  s_mov_b32 s87, 0x20000
  s_cmp_eq_u32 s3, 0
  s_cbranch_scc1 L_h0
  s_cmp_eq_u32 s3, 3
  s_cbranch_scc1 L_h3
  s_mov_b32 s52, s16
  s_mov_b32 s53, s17
  s_mov_b32 s54, 0x1c00
  s_mov_b32 s55, 0x20000
  v_and_b32 v8, 31, v0
  v_lshrrev_b32 v9, 5, v0
  v_mul_u32_u24 v9, 896, v9
  v_lshl_add_u32 v9, v8, 5, v9
  v_cmp_gt_u32 vcc, 28, v8
  v_mov_b32 v10, 0x7fffff00
  s_sub_u32 s16, s3, 1
  s_mul_i32 s16, s16, 3584
  v_cndmask_b32 v10, v10, v9, vcc
  v_mov_b32 v15, 1.0
  v_cndmask_b32 v15, 0, v15, vcc
  buffer_load_dwordx4 v[16:19], v10, s[52:55], s16 offen
  buffer_load_dwordx4 v[20:23], v10, s[52:55], s16 offen offset:16
  buffer_load_dwordx4 v[24:27], v10, s[52:55], s16 offen offset:1792
  buffer_load_dwordx4 v[28:31], v10, s[52:55], s16 offen offset:1808
  v_mov_b32 v12, 0
  v_lshlrev_b32 v13, 2, v2
  v_add_u32 v13, 140416, v13
  ds_write_b32 v13, v12
  s_add_u32 s16, s16, 148992
  v_add_u32 v9, s16, v9
  s_waitcnt lgkmcnt(0)
  s_barrier
  s_waitcnt vmcnt(0)
  s_mov_b32 s10, 0x3b124925
  s_mov_b32 s11, 0xc3e00000
  v_lshlrev_b32 v32, 16, v16
  v_lshlrev_b32 v80, 16, v24
  v_and_b32 v33, 0xffff0000, v16
  v_and_b32 v81, 0xffff0000, v24
  v_lshlrev_b32 v34, 16, v17
  v_lshlrev_b32 v82, 16, v25
  v_and_b32 v35, 0xffff0000, v17
  v_and_b32 v83, 0xffff0000, v25
  v_lshlrev_b32 v36, 16, v18
  v_lshlrev_b32 v84, 16, v26
  v_and_b32 v37, 0xffff0000, v18
  v_and_b32 v85, 0xffff0000, v26
  v_lshlrev_b32 v38, 16, v19
  v_lshlrev_b32 v86, 16, v27
  v_and_b32 v39, 0xffff0000, v19
  v_and_b32 v87, 0xffff0000, v27
  v_lshlrev_b32 v40, 16, v20
  v_lshlrev_b32 v88, 16, v28
  v_and_b32 v41, 0xffff0000, v20
  v_and_b32 v89, 0xffff0000, v28
  v_lshlrev_b32 v42, 16, v21
  v_lshlrev_b32 v90, 16, v29
  v_and_b32 v43, 0xffff0000, v21
  v_and_b32 v91, 0xffff0000, v29
  v_lshlrev_b32 v44, 16, v22
  v_lshlrev_b32 v92, 16, v30
  v_and_b32 v45, 0xffff0000, v22
  v_and_b32 v93, 0xffff0000, v30
  v_lshlrev_b32 v46, 16, v23
  v_lshlrev_b32 v94, 16, v31
  v_and_b32 v47, 0xffff0000, v23
  v_and_b32 v95, 0xffff0000, v31
  v_add_f32 v48, v32, v33
  v_add_f32 v96, v80, v81
  v_add_f32 v49, v34, v35
  v_add_f32 v97, v82, v83
  v_add_f32 v50, v36, v37
  v_add_f32 v98, v84, v85
  v_add_f32 v51, v38, v39
  v_add_f32 v99, v86, v87
  v_add_f32 v52, v40, v41
  v_add_f32 v100, v88, v89
  v_add_f32 v53, v42, v43
  v_add_f32 v101, v90, v91
  v_add_f32 v54, v44, v45
  v_add_f32 v102, v92, v93
  v_add_f32 v55, v46, v47
  v_add_f32 v103, v94, v95
  v_add_f32 v56, v48, v49
  v_add_f32 v104, v96, v97
  v_add_f32 v57, v50, v51
  v_add_f32 v105, v98, v99
  v_add_f32 v58, v52, v53
  v_add_f32 v106, v100, v101
  v_add_f32 v59, v54, v55
  v_add_f32 v107, v102, v103
  v_add_f32 v60, v56, v57
  v_add_f32 v108, v104, v105
  v_add_f32 v61, v58, v59
  v_add_f32 v109, v106, v107
  v_add_f32 v64, v60, v61
  v_add_f32 v112, v108, v109
  s_nop 0
  v_add_f32_dpp v64, v64, v64 quad_perm:[1,0,3,2] row_mask:0xf bank_mask:0xf
  v_add_f32_dpp v112, v112, v112 quad_perm:[1,0,3,2] row_mask:0xf bank_mask:0xf
  s_nop 0
  v_add_f32_dpp v64, v64, v64 quad_perm:[2,3,0,1] row_mask:0xf bank_mask:0xf
  v_add_f32_dpp v112, v112, v112 quad_perm:[2,3,0,1] row_mask:0xf bank_mask:0xf
  s_nop 0
  v_add_f32_dpp v64, v64, v64 row_half_mirror row_mask:0xf bank_mask:0xf
  v_add_f32_dpp v112, v112, v112 row_half_mirror row_mask:0xf bank_mask:0xf
  s_nop 0
  v_add_f32_dpp v64, v64, v64 row_mirror row_mask:0xf bank_mask:0xf
  v_add_f32_dpp v112, v112, v112 row_mirror row_mask:0xf bank_mask:0xf
  v_mov_b32 v65, v64
  v_mov_b32 v113, v112
  s_nop 0
  v_permlane16_swap_b32 v64, v65
  v_permlane16_swap_b32 v112, v113
  s_nop 0
  v_add_f32 v64, v64, v65
  v_add_f32 v112, v112, v113
  v_mul_f32 v65, 0x3b124925, v64
  v_mul_f32 v113, 0x3b124925, v112
  v_fma_f32 v64, v65, s11, v64
  v_fma_f32 v112, v113, s11, v112
  v_fma_f32 v64, v64, s10, v65
  v_fma_f32 v112, v112, s10, v113
  v_sub_f32 v48, v32, v64
  v_sub_f32 v96, v80, v112
  v_sub_f32 v49, v33, v64
  v_sub_f32 v97, v81, v112
  v_sub_f32 v50, v34, v64
  v_sub_f32 v98, v82, v112
  v_sub_f32 v51, v35, v64
  v_sub_f32 v99, v83, v112
  v_sub_f32 v52, v36, v64
  v_sub_f32 v100, v84, v112
  v_sub_f32 v53, v37, v64
  v_sub_f32 v101, v85, v112
  v_sub_f32 v54, v38, v64
  v_sub_f32 v102, v86, v112
  v_sub_f32 v55, v39, v64
  v_sub_f32 v103, v87, v112
  v_sub_f32 v56, v40, v64
  v_sub_f32 v104, v88, v112
  v_sub_f32 v57, v41, v64
  v_sub_f32 v105, v89, v112
  v_sub_f32 v58, v42, v64
  v_sub_f32 v106, v90, v112
  v_sub_f32 v59, v43, v64
  v_sub_f32 v107, v91, v112
  v_sub_f32 v60, v44, v64
  v_sub_f32 v108, v92, v112
  v_sub_f32 v61, v45, v64
  v_sub_f32 v109, v93, v112
  v_sub_f32 v62, v46, v64
  v_sub_f32 v110, v94, v112
  v_sub_f32 v63, v47, v64
  v_sub_f32 v111, v95, v112
  v_mul_f32 v48, v48, v48
  v_mul_f32 v96, v96, v96
  v_mul_f32 v49, v49, v49
  v_mul_f32 v97, v97, v97
  v_mul_f32 v50, v50, v50
  v_mul_f32 v98, v98, v98
  v_mul_f32 v51, v51, v51
  v_mul_f32 v99, v99, v99
  v_mul_f32 v52, v52, v52
  v_mul_f32 v100, v100, v100
  v_mul_f32 v53, v53, v53
  v_mul_f32 v101, v101, v101
  v_mul_f32 v54, v54, v54
  v_mul_f32 v102, v102, v102
  v_mul_f32 v55, v55, v55
  v_mul_f32 v103, v103, v103
  v_fma_f32 v48, v56, v56, v48
  v_fma_f32 v96, v104, v104, v96
  v_fma_f32 v49, v57, v57, v49
  v_fma_f32 v97, v105, v105, v97
  v_fma_f32 v50, v58, v58, v50
  v_fma_f32 v98, v106, v106, v98
  v_fma_f32 v51, v59, v59, v51
  v_fma_f32 v99, v107, v107, v99
  v_fma_f32 v52, v60, v60, v52
  v_fma_f32 v100, v108, v108, v100
  v_fma_f32 v53, v61, v61, v53
  v_fma_f32 v101, v109, v109, v101
  v_fma_f32 v54, v62, v62, v54
  v_fma_f32 v102, v110, v110, v102
  v_fma_f32 v55, v63, v63, v55
  v_fma_f32 v103, v111, v111, v103
  v_add_f32 v56, v48, v49
  v_add_f32 v104, v96, v97
  v_add_f32 v57, v50, v51
  v_add_f32 v105, v98, v99
  v_add_f32 v58, v52, v53
  v_add_f32 v106, v100, v101
  v_add_f32 v59, v54, v55
  v_add_f32 v107, v102, v103
  v_add_f32 v60, v56, v57
  v_add_f32 v108, v104, v105
  v_add_f32 v61, v58, v59
  v_add_f32 v109, v106, v107
  v_add_f32 v66, v60, v61
  v_add_f32 v114, v108, v109
  v_cvt_pk_bf16_f32 v64, v64, v64
  v_cvt_pk_bf16_f32 v112, v112, v112
  v_mul_f32 v66, v66, v15
  v_mul_f32 v114, v114, v15
  v_and_b32 v64, 0xffff0000, v64
  v_and_b32 v112, 0xffff0000, v112
  v_sub_f32 v32, v32, v64
  v_sub_f32 v80, v80, v112
  v_sub_f32 v33, v33, v64
  v_sub_f32 v81, v81, v112
  v_add_f32_dpp v66, v66, v66 quad_perm:[1,0,3,2] row_mask:0xf bank_mask:0xf
  v_add_f32_dpp v114, v114, v114 quad_perm:[1,0,3,2] row_mask:0xf bank_mask:0xf
  v_sub_f32 v34, v34, v64
  v_sub_f32 v82, v82, v112
  v_sub_f32 v35, v35, v64
  v_sub_f32 v83, v83, v112
  v_add_f32_dpp v66, v66, v66 quad_perm:[2,3,0,1] row_mask:0xf bank_mask:0xf
  v_add_f32_dpp v114, v114, v114 quad_perm:[2,3,0,1] row_mask:0xf bank_mask:0xf
  v_sub_f32 v36, v36, v64
  v_sub_f32 v84, v84, v112
  v_sub_f32 v37, v37, v64
  v_sub_f32 v85, v85, v112
  v_add_f32_dpp v66, v66, v66 row_half_mirror row_mask:0xf bank_mask:0xf
  v_add_f32_dpp v114, v114, v114 row_half_mirror row_mask:0xf bank_mask:0xf
  v_sub_f32 v38, v38, v64
  v_sub_f32 v86, v86, v112
  v_sub_f32 v39, v39, v64
  v_sub_f32 v87, v87, v112
  v_add_f32_dpp v66, v66, v66 row_mirror row_mask:0xf bank_mask:0xf
  v_add_f32_dpp v114, v114, v114 row_mirror row_mask:0xf bank_mask:0xf
  v_mov_b32 v65, v66
  v_mov_b32 v113, v114
  v_sub_f32 v40, v40, v64
  v_sub_f32 v88, v88, v112
  v_sub_f32 v41, v41, v64
  v_sub_f32 v89, v89, v112
  v_permlane16_swap_b32 v66, v65
  v_permlane16_swap_b32 v114, v113
  v_sub_f32 v42, v42, v64
  v_sub_f32 v90, v90, v112
  v_sub_f32 v43, v43, v64
  v_sub_f32 v91, v91, v112
  v_add_f32 v66, v66, v65
  v_add_f32 v114, v114, v113
  v_mul_f32 v65, 0x3b124925, v66
  v_mul_f32 v113, 0x3b124925, v114
  v_fma_f32 v66, v65, s11, v66
  v_fma_f32 v114, v113, s11, v114
  v_fma_f32 v66, v66, s10, v65
  v_fma_f32 v114, v114, s10, v113
  v_cvt_pk_bf16_f32 v66, v66, v66
  v_cvt_pk_bf16_f32 v114, v114, v114
  v_and_b32 v66, 0xffff0000, v66
  v_and_b32 v114, 0xffff0000, v114
  v_add_f32 v66, 0x3727c5ac, v66
  v_add_f32 v114, 0x3727c5ac, v114
  v_cvt_pk_bf16_f32 v66, v66, v66
  v_cvt_pk_bf16_f32 v114, v114, v114
  v_and_b32 v66, 0xffff0000, v66
  v_and_b32 v114, 0xffff0000, v114
  v_sqrt_f32 v66, v66
  v_sqrt_f32 v114, v114
  v_sub_f32 v44, v44, v64
  v_sub_f32 v92, v92, v112
  v_cvt_pk_bf16_f32 v66, v66, v66
  v_cvt_pk_bf16_f32 v114, v114, v114
  v_and_b32 v66, 0xffff0000, v66
  v_and_b32 v114, 0xffff0000, v114
  v_rcp_f32 v66, v66
  v_rcp_f32 v114, v114
  v_sub_f32 v45, v45, v64
  v_sub_f32 v93, v93, v112
  v_sub_f32 v46, v46, v64
  v_sub_f32 v94, v94, v112
  v_sub_f32 v47, v47, v64
  v_sub_f32 v95, v95, v112
  v_cvt_pk_bf16_f32 v16, v32, v33
  v_cvt_pk_bf16_f32 v24, v80, v81
  v_cvt_pk_bf16_f32 v17, v34, v35
  v_cvt_pk_bf16_f32 v25, v82, v83
  v_cvt_pk_bf16_f32 v18, v36, v37
  v_cvt_pk_bf16_f32 v26, v84, v85
  v_cvt_pk_bf16_f32 v19, v38, v39
  v_cvt_pk_bf16_f32 v27, v86, v87
  v_cvt_pk_bf16_f32 v20, v40, v41
  v_cvt_pk_bf16_f32 v28, v88, v89
  v_cvt_pk_bf16_f32 v21, v42, v43
  v_cvt_pk_bf16_f32 v29, v90, v91
  v_cvt_pk_bf16_f32 v22, v44, v45
  v_cvt_pk_bf16_f32 v30, v92, v93
  v_cvt_pk_bf16_f32 v23, v46, v47
  v_cvt_pk_bf16_f32 v31, v94, v95
  v_lshlrev_b32 v32, 16, v16
  v_lshlrev_b32 v80, 16, v24
  v_and_b32 v33, 0xffff0000, v16
  v_and_b32 v81, 0xffff0000, v24
  v_lshlrev_b32 v34, 16, v17
  v_lshlrev_b32 v82, 16, v25
  v_and_b32 v35, 0xffff0000, v17
  v_and_b32 v83, 0xffff0000, v25
  v_lshlrev_b32 v36, 16, v18
  v_lshlrev_b32 v84, 16, v26
  v_and_b32 v37, 0xffff0000, v18
  v_and_b32 v85, 0xffff0000, v26
  v_lshlrev_b32 v38, 16, v19
  v_lshlrev_b32 v86, 16, v27
  v_and_b32 v39, 0xffff0000, v19
  v_and_b32 v87, 0xffff0000, v27
  v_lshlrev_b32 v40, 16, v20
  v_lshlrev_b32 v88, 16, v28
  v_and_b32 v41, 0xffff0000, v20
  v_and_b32 v89, 0xffff0000, v28
  v_lshlrev_b32 v42, 16, v21
  v_lshlrev_b32 v90, 16, v29
  v_and_b32 v43, 0xffff0000, v21
  v_and_b32 v91, 0xffff0000, v29
  v_lshlrev_b32 v44, 16, v22
  v_lshlrev_b32 v92, 16, v30
  v_and_b32 v45, 0xffff0000, v22
  v_and_b32 v93, 0xffff0000, v30
  v_lshlrev_b32 v46, 16, v23
  v_lshlrev_b32 v94, 16, v31
  v_and_b32 v47, 0xffff0000, v23
  v_and_b32 v95, 0xffff0000, v31
  s_nop 0
  v_mul_f32 v32, v32, v66
  v_mul_f32 v80, v80, v114
  v_mul_f32 v33, v33, v66
  v_mul_f32 v81, v81, v114
  v_mul_f32 v34, v34, v66
  v_mul_f32 v82, v82, v114
  v_mul_f32 v35, v35, v66
  v_mul_f32 v83, v83, v114
  v_mul_f32 v36, v36, v66
  v_mul_f32 v84, v84, v114
  v_mul_f32 v37, v37, v66
  v_mul_f32 v85, v85, v114
  v_mul_f32 v38, v38, v66
  v_mul_f32 v86, v86, v114
  v_mul_f32 v39, v39, v66
  v_mul_f32 v87, v87, v114
  v_mul_f32 v40, v40, v66
  v_mul_f32 v88, v88, v114
  v_mul_f32 v41, v41, v66
  v_mul_f32 v89, v89, v114
  v_mul_f32 v42, v42, v66
  v_mul_f32 v90, v90, v114
  v_mul_f32 v43, v43, v66
  v_mul_f32 v91, v91, v114
  v_mul_f32 v44, v44, v66
  v_mul_f32 v92, v92, v114
  v_mul_f32 v45, v45, v66
  v_mul_f32 v93, v93, v114
  v_mul_f32 v46, v46, v66
  v_mul_f32 v94, v94, v114
  v_mul_f32 v47, v47, v66
  v_mul_f32 v95, v95, v114
  v_cvt_pk_bf16_f32 v16, v32, v33
  v_cvt_pk_bf16_f32 v24, v80, v81
  v_cvt_pk_bf16_f32 v17, v34, v35
  v_cvt_pk_bf16_f32 v25, v82, v83
  v_cvt_pk_bf16_f32 v18, v36, v37
  v_cvt_pk_bf16_f32 v26, v84, v85
  v_cvt_pk_bf16_f32 v19, v38, v39
  v_cvt_pk_bf16_f32 v27, v86, v87
  v_cvt_pk_bf16_f32 v20, v40, v41
  v_cvt_pk_bf16_f32 v28, v88, v89
  v_cvt_pk_bf16_f32 v21, v42, v43
  v_cvt_pk_bf16_f32 v29, v90, v91
  v_cvt_pk_bf16_f32 v22, v44, v45
  v_cvt_pk_bf16_f32 v30, v92, v93
  v_cvt_pk_bf16_f32 v23, v46, v47
  v_cvt_pk_bf16_f32 v31, v94, v95
  v_cmp_lt_f32 vcc, 0, v15
  s_and_saveexec_b64 s[42:43], vcc
  ds_write_b128 v9, v[16:19]
  ds_write_b128 v9, v[20:23] offset:16
  ds_write_b128 v9, v[24:27] offset:1792
  ds_write_b128 v9, v[28:31] offset:1808
  s_mov_b64 exec, s[42:43]
  v_mov_b32 v9, 140432
  v_mov_b32 v10, 1
  s_mov_b64 exec, 1
  ds_add_u32 v9, v10
  s_mov_b64 exec, -1
  s_branch L_hb2
L_h0:
  v_lshrrev_b32 v13, 1, v0
  v_lshlrev_b32 v13, 13, v13
  v_and_b32 v14, 1, v0
  v_lshl_add_u32 v13, v14, 4, v13
  s_lshl_b32 s10, s11, 5
  s_barrier
  s_mov_b32 m0, 0
  s_add_u32 s15, s10, 0
  buffer_load_dwordx4 v13, s[56:59], s15 offen  lds
  s_mov_b32 m0, 1024
  s_add_u32 s15, s10, 262144
  buffer_load_dwordx4 v13, s[56:59], s15 offen  lds
  s_mov_b32 m0, 2048
  s_add_u32 s15, s10, 524288
  buffer_load_dwordx4 v13, s[56:59], s15 offen  lds
  s_mov_b32 m0, 3072
  s_add_u32 s15, s10, 786432
  buffer_load_dwordx4 v13, s[56:59], s15 offen  lds
  s_mov_b32 m0, 4096
  s_add_u32 s15, s10, 1048576
  buffer_load_dwordx4 v13, s[56:59], s15 offen  lds
  s_mov_b32 m0, 5120
  s_add_u32 s15, s10, 1310720
  buffer_load_dwordx4 v13, s[56:59], s15 offen  lds
  s_mov_b32 m0, 6144
  s_add_u32 s15, s10, 1572864
  buffer_load_dwordx4 v13, s[56:59], s15 offen  lds
  s_mov_b32 m0, 7168
  s_add_u32 s15, s10, 1835008
  buffer_load_dwordx4 v13, s[56:59], s15 offen  lds
  s_mov_b32 m0, 8192
  s_add_u32 s15, s10, 2097152
  buffer_load_dwordx4 v13, s[56:59], s15 offen  lds
  s_mov_b32 m0, 9216
  s_add_u32 s15, s10, 2359296
  buffer_load_dwordx4 v13, s[56:59], s15 offen  lds
  s_mov_b32 m0, 10240
  s_add_u32 s15, s10, 2621440
  buffer_load_dwordx4 v13, s[56:59], s15 offen  lds
  s_mov_b32 m0, 11264
  s_add_u32 s15, s10, 2883584
  buffer_load_dwordx4 v13, s[56:59], s15 offen  lds
  s_mov_b32 m0, 12288
  s_add_u32 s15, s10, 3145728
  buffer_load_dwordx4 v13, s[56:59], s15 offen  lds
  s_mov_b32 m0, 13312
  s_add_u32 s15, s10, 3407872
  buffer_load_dwordx4 v13, s[56:59], s15 offen  lds
  v_lshrrev_b32 v12, 2, v2
  v_lshl_add_u32 v12, v3, 3, v12
  v_lshlrev_b32 v12, 5, v12
  v_and_b32 v13, 3, v2
  v_lshl_add_u32 v12, v13, 3, v12
  v_and_b32 v13, 7, v2
  v_mul_u32_u24 v13, 896, v13
  v_lshl_add_u32 v13, v3, 4, v13
  v_add_u32 v13, 148992, v13
  v_lshlrev_b32 v14, 13, v2
  v_lshl_add_u32 v14, v3, 3, v14
  s_waitcnt vmcnt(0)
  ds_read_b64_tr_b16 v[80:81], v12 offset:0
  ds_read_b64_tr_b16 v[82:83], v12 offset:128
  ds_read_b64_tr_b16 v[84:85], v12 offset:1024
  ds_read_b64_tr_b16 v[86:87], v12 offset:1152
  ds_read_b64_tr_b16 v[88:89], v12 offset:2048
  ds_read_b64_tr_b16 v[90:91], v12 offset:2176
  ds_read_b64_tr_b16 v[92:93], v12 offset:3072
  ds_read_b64_tr_b16 v[94:95], v12 offset:3200
  ds_read_b64_tr_b16 v[96:97], v12 offset:4096
  ds_read_b64_tr_b16 v[98:99], v12 offset:4224
  ds_read_b64_tr_b16 v[100:101], v12 offset:5120
  ds_read_b64_tr_b16 v[102:103], v12 offset:5248
  ds_read_b64_tr_b16 v[104:105], v12 offset:6144
  ds_read_b64_tr_b16 v[106:107], v12 offset:6272
  s_waitcnt lgkmcnt(0)
  ds_read_b64_tr_b16 v[108:109], v12 offset:7168
  ds_read_b64_tr_b16 v[110:111], v12 offset:7296
  ds_read_b64_tr_b16 v[112:113], v12 offset:8192
  ds_read_b64_tr_b16 v[114:115], v12 offset:8320
  ds_read_b64_tr_b16 v[116:117], v12 offset:9216
  ds_read_b64_tr_b16 v[118:119], v12 offset:9344
  ds_read_b64_tr_b16 v[120:121], v12 offset:10240
  ds_read_b64_tr_b16 v[122:123], v12 offset:10368
  ds_read_b64_tr_b16 v[124:125], v12 offset:11264
  ds_read_b64_tr_b16 v[126:127], v12 offset:11392
  ds_read_b64_tr_b16 v[128:129], v12 offset:12288
  ds_read_b64_tr_b16 v[130:131], v12 offset:12416
  ds_read_b64_tr_b16 v[132:133], v12 offset:13312
  ds_read_b64_tr_b16 v[134:135], v12 offset:13440
  s_waitcnt lgkmcnt(0)
  v_mov_b32 v15, 140432
  s_mov_b32 s15, 1048576
L_lw_119:
  ds_read_b32 v16, v15
  s_waitcnt lgkmcnt(0)
  v_cmp_gt_u32 vcc, 3, v16
  s_cbranch_vccz L_lwd_120
  s_sub_u32 s15, s15, 1
  s_cmp_lg_u32 s15, 0
  s_cbranch_scc1 L_lw_119
L_lwd_120:
  ds_read_b128 v[144:147], v13 offset:0
  ds_read_b128 v[148:151], v13 offset:64
  ds_read_b128 v[152:155], v13 offset:128
  ds_read_b128 v[156:159], v13 offset:192
  ds_read_b128 v[160:163], v13 offset:256
  ds_read_b128 v[164:167], v13 offset:320
  ds_read_b128 v[168:171], v13 offset:384
  ds_read_b128 v[172:175], v13 offset:448
  ds_read_b128 v[176:179], v13 offset:512
  ds_read_b128 v[180:183], v13 offset:576
  ds_read_b128 v[184:187], v13 offset:640
  ds_read_b128 v[188:191], v13 offset:704
  ds_read_b128 v[192:195], v13 offset:768
  ds_read_b128 v[196:199], v13 offset:832
  s_waitcnt lgkmcnt(13)
  v_mfma_f32_16x16x32_bf16 v[24:27], v[80:83], v[144:147], 0
  s_waitcnt lgkmcnt(12)
  v_mfma_f32_16x16x32_bf16 v[24:27], v[84:87], v[148:151], v[24:27]
  s_waitcnt lgkmcnt(11)
  v_mfma_f32_16x16x32_bf16 v[24:27], v[88:91], v[152:155], v[24:27]
  s_waitcnt lgkmcnt(10)
  v_mfma_f32_16x16x32_bf16 v[24:27], v[92:95], v[156:159], v[24:27]
  s_waitcnt lgkmcnt(9)
  v_mfma_f32_16x16x32_bf16 v[24:27], v[96:99], v[160:163], v[24:27]
  s_waitcnt lgkmcnt(8)
  v_mfma_f32_16x16x32_bf16 v[24:27], v[100:103], v[164:167], v[24:27]
  s_waitcnt lgkmcnt(7)
  v_mfma_f32_16x16x32_bf16 v[24:27], v[104:107], v[168:171], v[24:27]
  s_waitcnt lgkmcnt(6)
  v_mfma_f32_16x16x32_bf16 v[24:27], v[108:111], v[172:175], v[24:27]
  s_waitcnt lgkmcnt(5)
  v_mfma_f32_16x16x32_bf16 v[24:27], v[112:115], v[176:179], v[24:27]
  s_waitcnt lgkmcnt(4)
  v_mfma_f32_16x16x32_bf16 v[24:27], v[116:119], v[180:183], v[24:27]
  s_waitcnt lgkmcnt(3)
  v_mfma_f32_16x16x32_bf16 v[24:27], v[120:123], v[184:187], v[24:27]
  s_waitcnt lgkmcnt(2)
  v_mfma_f32_16x16x32_bf16 v[24:27], v[124:127], v[188:191], v[24:27]
  s_waitcnt lgkmcnt(1)
  v_mfma_f32_16x16x32_bf16 v[24:27], v[128:131], v[192:195], v[24:27]
  s_waitcnt lgkmcnt(0)
  v_mfma_f32_16x16x32_bf16 v[24:27], v[132:135], v[196:199], v[24:27]
  s_mov_b32 exec_lo, 0x00ff00ff
  s_mov_b32 exec_hi, 0x00ff00ff
  s_nop 5
  v_cvt_pk_bf16_f32 v28, v24, v25
  v_cvt_pk_bf16_f32 v29, v26, v27
  v_min_u32 v28, -2, v28
  v_min_u32 v29, -2, v29
  buffer_store_dwordx2 v[28:29], v14, s[88:91], s10 offen sc1
  s_mov_b64 exec, -1
  s_branch L_hb2
L_h3:
  v_mov_b32 v24, -1
  v_mov_b32 v25, -1
  v_mov_b32 v26, -1
  v_mov_b32 v27, -1
  v_lshrrev_b32 v14, 1, v0
  v_lshlrev_b32 v14, 13, v14
  v_and_b32 v15, 1, v0
  v_lshl_add_u32 v14, v15, 4, v14
  s_lshl_b32 s10, s11, 5
  s_mov_b64 exec, 0xffff
  buffer_store_dwordx4 v[24:27], v14, s[88:91], s10 offen sc1
  s_mov_b64 exec, -1
  v_lshlrev_b32 v14, 4, v0
  s_lshl_b32 s16, s7, 7
  s_add_u32 s16, s16, 589824
  s_mov_b64 exec, 0xff
  buffer_store_dwordx4 v[24:27], v14, s[88:91], s16 offen sc1
  s_mov_b64 exec, -1
  s_lshl_b32 s10, s7, 11
  s_add_u32 s10, s10, 65536
  buffer_store_dwordx4 v[24:27], v14, s[88:91], s10 offen offset:0 sc1
  buffer_store_dwordx4 v[24:27], v14, s[88:91], s10 offen offset:1024 sc1
  s_lshl_b32 s10, s7, 9
  s_add_u32 s10, s10, 655360
  s_mov_b32 exec_hi, 0
  buffer_store_dwordx4 v[24:27], v14, s[88:91], s10 offen sc1
  s_mov_b64 exec, -1
  s_lshl_b32 s10, s7, 11
  s_add_u32 s10, s10, 1310720
  buffer_store_dwordx4 v[24:27], v14, s[88:91], s10 offen offset:0 sc1
  s_cmp_ge_u32 s13, 28
  s_cbranch_scc1 L_noclr3_121
  s_lshl_b32 s10, s5, 5
  s_add_u32 s10, s10, s13
  s_lshl_b32 s10, s10, 11
  s_add_u32 s10, s10, 786432
  buffer_store_dwordx4 v[24:27], v14, s[88:91], s10 offen offset:0 sc1
  buffer_store_dwordx4 v[24:27], v14, s[88:91], s10 offen offset:1024 sc1
L_noclr3_121:
  s_barrier
  v_mov_b32 v12, 1
  v_mov_b32 v13, 0
  v_mov_b32 v15, 1
  s_lshl_b32 s19, s4, 5
  v_lshrrev_b32 v16, 2, v0
  v_lshlrev_b32 v16, 5, v16
  v_and_b32 v17, 3, v0
  v_add_u32 v16, v16, v17
  v_lshlrev_b32 v16, 7, v16
  v_lshlrev_b32 v17, 7, v0
  s_waitcnt vmcnt(0)
  s_mov_b64 exec, 1
  buffer_atomic_add v12, v13, s[84:87], s19 offen sc0 sc1
  s_mov_b64 exec, -1
  v_mov_b32 v18, 140432
  v_mov_b32 v19, 1
  s_mov_b64 exec, 1
  ds_add_u32 v18, v19
  s_mov_b64 exec, -1
  s_waitcnt vmcnt(0)
  v_readfirstlane_b32 s17, v12
  s_nop 3
  s_and_b32 s17, s17, 31
  s_cmp_lg_u32 s17, 31
  s_cbranch_scc1 L_notlast
  s_lshl_b32 s19, s4, 9
  s_add_u32 s19, s19, 589888
  s_mov_b32 exec_hi, 0
  buffer_store_dword v15, v16, s[88:91], s19 offen sc1
  v_mov_b32 v12, 1
  s_mov_b64 exec, 1
  buffer_atomic_add v12, v13, s[84:87], 0 offen offset:16 sc0 sc1
  s_mov_b64 exec, -1
  s_waitcnt vmcnt(0)
  v_readfirstlane_b32 s17, v12
  s_nop 3
  s_and_b32 s17, s17, 7
  s_cmp_lg_u32 s17, 7
  s_cbranch_scc1 L_notlast
  s_mov_b32 s19, 589920
  buffer_store_dword v15, v17, s[88:91], s19 offen sc1
  s_mov_b32 s19, 598112
  buffer_store_dword v15, v17, s[88:91], s19 offen sc1
  s_mov_b32 s19, 606304
  buffer_store_dword v15, v17, s[88:91], s19 offen sc1
  s_mov_b32 s19, 614496
  buffer_store_dword v15, v17, s[88:91], s19 offen sc1
L_notlast:
  s_mov_b32 s15, 1048576
L_p_122:
  buffer_load_dword v18, v13, s[88:91], s16 offen offset:64 sc1
  s_waitcnt vmcnt(0)
  v_cmp_eq_u32 vcc, -1, v18
  s_cbranch_vccz L_pd_123
  s_sub_u32 s15, s15, 1
  s_cmp_lg_u32 s15, 0
  s_cbranch_scc1 L_p_122
L_pd_123:
  s_lshl_b32 s19, s5, 13
  s_lshl_b32 s17, s4, 10
  s_add_u32 s19, s19, s17
  v_add_u32 v12, 131072, v14
  s_mov_b32 s15, 1048576
L_p_124:
  buffer_load_dwordx4 v[16:19], v14, s[88:91], s19 offen sc1
  s_waitcnt vmcnt(0)
  v_max3_u32 v24, v16, v17, v18
  v_max_u32 v24, v24, v19
  v_cmp_eq_u32 vcc, -1, v24
  s_cbranch_vccz L_pd_125
  s_sub_u32 s15, s15, 1
  s_cmp_lg_u32 s15, 0
  s_cbranch_scc1 L_p_124
L_pd_125:
  ds_write_b128 v12, v[16:19]
  s_waitcnt lgkmcnt(0)
  s_barrier
  s_mov_b32 s15, 1048576
L_p_126:
  buffer_load_dword v18, v13, s[88:91], s16 offen offset:96 sc1
  s_waitcnt vmcnt(0)
  v_cmp_eq_u32 vcc, -1, v18
  s_cbranch_vccz L_pd_127
  s_sub_u32 s15, s15, 1
  s_cmp_lg_u32 s15, 0
  s_cbranch_scc1 L_p_126
L_pd_127:
  s_branch L_hw
L_hb2:
  s_barrier
L_hw:
  s_load_dwordx2 s[16:17], s[0:1], 0
  s_load_dwordx2 s[24:25], s[0:1], 32
  s_load_dwordx4 s[20:23], s[0:1], 48
  s_load_dwordx2 s[18:19], s[0:1], 64
  s_load_dwordx4 s[64:67], s[0:1], 72
  s_waitcnt lgkmcnt(0)
  s_mov_b32 s52, s16
  s_mov_b32 s53, s17
  s_mov_b32 s54, 0x1c00
  s_mov_b32 s55, 0x20000
  s_mov_b32 s60, s24
  s_mov_b32 s61, s25
  s_mov_b32 s62, 0x380000
  s_mov_b32 s63, 0x20000
  s_mov_b32 s76, s64
  s_mov_b32 s77, s65
  s_mov_b32 s78, 0x380
  s_mov_b32 s79, 0x20000
  s_mov_b32 s80, s66
  s_mov_b32 s81, s67
  s_mov_b32 s82, 0x1c00
  s_mov_b32 s83, 0x20000
  s_mov_b32 s64, s20
  s_mov_b32 s65, s21
  s_mov_b32 s66, 0x188000
  s_mov_b32 s67, 0x20000
  s_mov_b32 s68, s22
  s_mov_b32 s69, s23
  s_mov_b32 s70, 0xe00
  s_mov_b32 s71, 0x20000
  s_mov_b32 s72, s18
  s_mov_b32 s73, s19
  s_mov_b32 s74, 0x188000
  s_mov_b32 s75, 0x20000
  v_and_b32 v12, 31, v0
  v_lshlrev_b32 v12, 3, v12
  s_mul_i32 s19, s5, 896
  s_lshl_b32 s16, s3, 8
  s_add_u32 s19, s19, s16
  buffer_load_dwordx2 v[64:65], v12, s[52:55], s19 offen
  v_lshlrev_b32 v12, 3, v3
  s_lshl_b32 s19, s13, 7
  s_lshl_b32 s16, s3, 5
  s_add_u32 s19, s19, s16
  buffer_load_dwordx2 v[66:67], v12, s[68:71], s19 offen
  v_and_b32 v12, 7, v0
  v_lshlrev_b32 v12, 2, v12
  s_lshl_b32 s19, s13, 5
  buffer_load_dword v68, v12, s[76:79], s19 offen
  v_lshrrev_b32 v8, 2, v2
  v_lshl_add_u32 v8, v3, 3, v8
  v_and_b32 v9, 3, v2
  s_cmp_ge_u32 s13, 28
  s_cbranch_scc1 L_noffn
  v_lshrrev_b32 v12, 3, v0
  v_mul_u32_u24 v12, 3584, v12
  v_and_b32 v13, 7, v0
  v_lshl_add_u32 v12, v13, 4, v12
  s_mul_i32 s16, s3, 401408
  s_lshl_b32 s19, s13, 7
  s_add_u32 s16, s16, s19
  s_mul_i32 s17, s3, 14336
  s_waitcnt vmcnt(4)
  s_add_u32 m0, s17, 0
  s_add_u32 s19, s16, 0
  buffer_load_dwordx4 v12, s[64:67], s19 offen  lds
  s_waitcnt vmcnt(4)
  s_add_u32 m0, s17, 1024
  s_add_u32 s19, s16, 28672
  buffer_load_dwordx4 v12, s[64:67], s19 offen  lds
  s_waitcnt vmcnt(4)
  s_add_u32 m0, s17, 2048
  s_add_u32 s19, s16, 57344
  buffer_load_dwordx4 v12, s[64:67], s19 offen  lds
  s_waitcnt vmcnt(4)
  s_add_u32 m0, s17, 3072
  s_add_u32 s19, s16, 86016
  buffer_load_dwordx4 v12, s[64:67], s19 offen  lds
  s_waitcnt vmcnt(4)
  s_add_u32 m0, s17, 4096
  s_add_u32 s19, s16, 114688
  buffer_load_dwordx4 v12, s[64:67], s19 offen  lds
  s_waitcnt vmcnt(4)
  s_add_u32 m0, s17, 5120
  s_add_u32 s19, s16, 143360
  buffer_load_dwordx4 v12, s[64:67], s19 offen  lds
  s_waitcnt vmcnt(4)
  s_add_u32 m0, s17, 6144
  s_add_u32 s19, s16, 172032
  buffer_load_dwordx4 v12, s[64:67], s19 offen  lds
  s_waitcnt vmcnt(4)
  s_add_u32 m0, s17, 7168
  s_add_u32 s19, s16, 200704
  buffer_load_dwordx4 v12, s[64:67], s19 offen  lds
  s_waitcnt vmcnt(4)
  s_add_u32 m0, s17, 8192
  s_add_u32 s19, s16, 229376
  buffer_load_dwordx4 v12, s[64:67], s19 offen  lds
  s_waitcnt vmcnt(4)
  s_add_u32 m0, s17, 9216
  s_add_u32 s19, s16, 258048
  buffer_load_dwordx4 v12, s[64:67], s19 offen  lds
  s_waitcnt vmcnt(4)
  s_add_u32 m0, s17, 10240
  s_add_u32 s19, s16, 286720
  buffer_load_dwordx4 v12, s[64:67], s19 offen  lds
  s_waitcnt vmcnt(4)
  s_add_u32 m0, s17, 11264
  s_add_u32 s19, s16, 315392
  buffer_load_dwordx4 v12, s[64:67], s19 offen  lds
  s_waitcnt vmcnt(4)
  s_add_u32 m0, s17, 12288
  s_add_u32 s19, s16, 344064
  buffer_load_dwordx4 v12, s[64:67], s19 offen  lds
  s_waitcnt vmcnt(4)
  s_add_u32 m0, s17, 13312
  s_add_u32 s19, s16, 372736
  buffer_load_dwordx4 v12, s[64:67], s19 offen  lds
  v_mov_b32 v13, 140436
  s_mov_b32 s15, 1048576
L_lw_128:
  ds_read_b32 v14, v13
  s_waitcnt lgkmcnt(0)
  v_cmp_gt_u32 vcc, 4, v14
  s_cbranch_vccz L_lwd_129
  s_sleep 2
  s_sub_u32 s15, s15, 1
  s_cmp_lg_u32 s15, 0
  s_cbranch_scc1 L_lw_128
L_lwd_129:
  v_lshlrev_b32 v12, 4, v0
  s_mul_i32 s16, s13, 57344
  s_add_u32 s16, s16, s17
  s_waitcnt vmcnt(4)
  s_add_u32 m0, s17, 65536
  s_add_u32 s19, s16, 0
  buffer_load_dwordx4 v12, s[72:75], s19 offen  lds
  s_waitcnt vmcnt(4)
  s_add_u32 m0, s17, 66560
  s_add_u32 s19, s16, 1024
  buffer_load_dwordx4 v12, s[72:75], s19 offen  lds
  s_waitcnt vmcnt(4)
  s_add_u32 m0, s17, 67584
  s_add_u32 s19, s16, 2048
  buffer_load_dwordx4 v12, s[72:75], s19 offen  lds
  s_waitcnt vmcnt(4)
  s_add_u32 m0, s17, 68608
  s_add_u32 s19, s16, 3072
  buffer_load_dwordx4 v12, s[72:75], s19 offen  lds
  s_waitcnt vmcnt(4)
  s_add_u32 m0, s17, 69632
  s_add_u32 s19, s16, 4096
  buffer_load_dwordx4 v12, s[72:75], s19 offen  lds
  s_waitcnt vmcnt(4)
  s_add_u32 m0, s17, 70656
  s_add_u32 s19, s16, 5120
  buffer_load_dwordx4 v12, s[72:75], s19 offen  lds
  s_waitcnt vmcnt(4)
  s_add_u32 m0, s17, 71680
  s_add_u32 s19, s16, 6144
  buffer_load_dwordx4 v12, s[72:75], s19 offen  lds
  s_waitcnt vmcnt(4)
  s_add_u32 m0, s17, 72704
  s_add_u32 s19, s16, 7168
  buffer_load_dwordx4 v12, s[72:75], s19 offen  lds
  s_waitcnt vmcnt(4)
  s_add_u32 m0, s17, 73728
  s_add_u32 s19, s16, 8192
  buffer_load_dwordx4 v12, s[72:75], s19 offen  lds
  s_waitcnt vmcnt(4)
  s_add_u32 m0, s17, 74752
  s_add_u32 s19, s16, 9216
  buffer_load_dwordx4 v12, s[72:75], s19 offen  lds
  s_waitcnt vmcnt(4)
  s_add_u32 m0, s17, 75776
  s_add_u32 s19, s16, 10240
  buffer_load_dwordx4 v12, s[72:75], s19 offen  lds
  s_waitcnt vmcnt(4)
  s_add_u32 m0, s17, 76800
  s_add_u32 s19, s16, 11264
  buffer_load_dwordx4 v12, s[72:75], s19 offen  lds
  s_waitcnt vmcnt(4)
  s_add_u32 m0, s17, 77824
  s_add_u32 s19, s16, 12288
  buffer_load_dwordx4 v12, s[72:75], s19 offen  lds
  s_waitcnt vmcnt(4)
  s_add_u32 m0, s17, 78848
  s_add_u32 s19, s16, 13312
  buffer_load_dwordx4 v12, s[72:75], s19 offen  lds
  s_waitcnt vmcnt(0)
  v_mov_b32 v12, 140424
  v_mov_b32 v13, 1
  s_mov_b64 exec, 1
  ds_add_u32 v12, v13
  s_mov_b64 exec, -1
  s_mov_b32 s15, 1048576
L_lw_130:
  ds_read_b32 v13, v12
  s_waitcnt lgkmcnt(0)
  v_cmp_gt_u32 vcc, 4, v13
  s_cbranch_vccz L_lwd_131
  s_sleep 2
  s_sub_u32 s15, s15, 1
  s_cmp_lg_u32 s15, 0
  s_cbranch_scc1 L_lw_130
L_lwd_131:
  v_lshlrev_b32 v12, 7, v8
  v_lshl_add_u32 v12, v9, 3, v12
  s_lshl_b32 s16, s3, 5
  v_add_u32 v12, s16, v12
  ds_read_b64_tr_b16 v[144:145], v12 offset:0
  ds_read_b64_tr_b16 v[146:147], v12 offset:512
  ds_read_b64_tr_b16 v[148:149], v12 offset:4096
  ds_read_b64_tr_b16 v[150:151], v12 offset:4608
  ds_read_b64_tr_b16 v[152:153], v12 offset:8192
  ds_read_b64_tr_b16 v[154:155], v12 offset:8704
  ds_read_b64_tr_b16 v[156:157], v12 offset:12288
  ds_read_b64_tr_b16 v[158:159], v12 offset:12800
  ds_read_b64_tr_b16 v[160:161], v12 offset:16384
  ds_read_b64_tr_b16 v[162:163], v12 offset:16896
  ds_read_b64_tr_b16 v[164:165], v12 offset:20480
  ds_read_b64_tr_b16 v[166:167], v12 offset:20992
  s_waitcnt lgkmcnt(0)
  ds_read_b64_tr_b16 v[168:169], v12 offset:24576
  ds_read_b64_tr_b16 v[170:171], v12 offset:25088
  ds_read_b64_tr_b16 v[172:173], v12 offset:28672
  ds_read_b64_tr_b16 v[174:175], v12 offset:29184
  ds_read_b64_tr_b16 v[176:177], v12 offset:32768
  ds_read_b64_tr_b16 v[178:179], v12 offset:33280
  ds_read_b64_tr_b16 v[180:181], v12 offset:36864
  ds_read_b64_tr_b16 v[182:183], v12 offset:37376
  ds_read_b64_tr_b16 v[184:185], v12 offset:40960
  ds_read_b64_tr_b16 v[186:187], v12 offset:41472
  ds_read_b64_tr_b16 v[188:189], v12 offset:45056
  ds_read_b64_tr_b16 v[190:191], v12 offset:45568
  s_waitcnt lgkmcnt(0)
  ds_read_b64_tr_b16 v[192:193], v12 offset:49152
  ds_read_b64_tr_b16 v[194:195], v12 offset:49664
  ds_read_b64_tr_b16 v[196:197], v12 offset:53248
  ds_read_b64_tr_b16 v[198:199], v12 offset:53760
  s_waitcnt lgkmcnt(0)
  v_mul_u32_u24 v12, 896, v8
  v_lshl_add_u32 v12, v9, 3, v12
  s_mul_i32 s16, s3, 224
  s_add_u32 s16, s16, 65536
  v_add_u32 v12, s16, v12
  ds_read_b64_tr_b16 v[200:201], v12 offset:0
  ds_read_b64_tr_b16 v[202:203], v12 offset:3584
  ds_read_b64_tr_b16 v[204:205], v12 offset:28672
  ds_read_b64_tr_b16 v[206:207], v12 offset:32256
  ds_read_b64_tr_b16 v[208:209], v12 offset:32
  ds_read_b64_tr_b16 v[210:211], v12 offset:3616
  ds_read_b64_tr_b16 v[212:213], v12 offset:28704
  ds_read_b64_tr_b16 v[214:215], v12 offset:32288
  ds_read_b64_tr_b16 v[216:217], v12 offset:64
  ds_read_b64_tr_b16 v[218:219], v12 offset:3648
  ds_read_b64_tr_b16 v[220:221], v12 offset:28736
  ds_read_b64_tr_b16 v[222:223], v12 offset:32320
  s_waitcnt lgkmcnt(0)
  ds_read_b64_tr_b16 v[224:225], v12 offset:96
  ds_read_b64_tr_b16 v[226:227], v12 offset:3680
  ds_read_b64_tr_b16 v[228:229], v12 offset:28768
  ds_read_b64_tr_b16 v[230:231], v12 offset:32352
  ds_read_b64_tr_b16 v[232:233], v12 offset:128
  ds_read_b64_tr_b16 v[234:235], v12 offset:3712
  ds_read_b64_tr_b16 v[236:237], v12 offset:28800
  ds_read_b64_tr_b16 v[238:239], v12 offset:32384
  ds_read_b64_tr_b16 v[240:241], v12 offset:160
  ds_read_b64_tr_b16 v[242:243], v12 offset:3744
  ds_read_b64_tr_b16 v[244:245], v12 offset:28832
  ds_read_b64_tr_b16 v[246:247], v12 offset:32416
  s_waitcnt lgkmcnt(0)
  ds_read_b64_tr_b16 v[248:249], v12 offset:192
  ds_read_b64_tr_b16 v[250:251], v12 offset:3776
  ds_read_b64_tr_b16 v[252:253], v12 offset:28864
  ds_read_b64_tr_b16 v[254:255], v12 offset:32448
  s_waitcnt lgkmcnt(0)
  v_mov_b32 v12, 140428
  v_mov_b32 v13, 1
  s_mov_b64 exec, 1
  ds_add_u32 v12, v13
  s_mov_b64 exec, -1
  s_mov_b32 s15, 1048576
L_lw_132:
  ds_read_b32 v13, v12
  s_waitcnt lgkmcnt(0)
  v_cmp_gt_u32 vcc, 4, v13
  s_cbranch_vccz L_lwd_133
  s_sleep 2
  s_sub_u32 s15, s15, 1
  s_cmp_lg_u32 s15, 0
  s_cbranch_scc1 L_lw_132
L_lwd_133:
L_noffn:
  v_mov_b32 v13, 140436
  s_mov_b32 s15, 1048576
L_lw_134:
  ds_read_b32 v14, v13
  s_waitcnt lgkmcnt(0)
  v_cmp_gt_u32 vcc, 4, v14
  s_cbranch_vccz L_lwd_135
  s_sleep 2
  s_sub_u32 s15, s15, 1
  s_cmp_lg_u32 s15, 0
  s_cbranch_scc1 L_lw_134
L_lwd_135:
  v_lshlrev_b32 v12, 1, v3
  v_xor_b32 v12, v12, v2
  v_xor_b32 v13, 8, v12
  s_cmp_eq_u32 s6, 3
  s_cselect_b32 s19, 8, 16
  v_cmp_gt_u32 s[20:21], s19, v12
  v_cmp_gt_u32 s[22:23], s19, v13
  v_mul_u32_u24 v14, 896, v3
  v_lshl_add_u32 v12, v12, 4, v14
  v_lshl_add_u32 v13, v13, 4, v14
  s_lshl_b32 s16, s4, 9
  s_mul_i32 s19, s3, 160
  s_add_u32 s16, s16, s19
  s_mul_i32 s16, s16, 896
  s_lshl_b32 s19, s6, 8
  s_add_u32 s16, s16, s19
  s_mul_i32 s17, s3, 40960
  s_waitcnt vmcnt(4)
  s_mov_b64 exec, s[20:21]
  s_add_u32 m0, s17, 0
  s_add_u32 s19, s16, 0
  buffer_load_dwordx4 v12, s[60:63], s19 offen  lds
  s_waitcnt vmcnt(4)
  s_add_u32 m0, s17, 1024
  s_add_u32 s19, s16, 3584
  buffer_load_dwordx4 v12, s[60:63], s19 offen  lds
  s_waitcnt vmcnt(4)
  s_mov_b64 exec, s[22:23]
  s_add_u32 m0, s17, 2048
  s_add_u32 s19, s16, 7168
  buffer_load_dwordx4 v13, s[60:63], s19 offen  lds
  s_waitcnt vmcnt(4)
  s_add_u32 m0, s17, 3072
  s_add_u32 s19, s16, 10752
  buffer_load_dwordx4 v13, s[60:63], s19 offen  lds
  s_waitcnt vmcnt(4)
  s_mov_b64 exec, s[20:21]
  s_add_u32 m0, s17, 4096
  s_add_u32 s19, s16, 14336
  buffer_load_dwordx4 v12, s[60:63], s19 offen  lds
  s_waitcnt vmcnt(4)
  s_add_u32 m0, s17, 5120
  s_add_u32 s19, s16, 17920
  buffer_load_dwordx4 v12, s[60:63], s19 offen  lds
  s_waitcnt vmcnt(4)
  s_mov_b64 exec, s[22:23]
  s_add_u32 m0, s17, 6144
  s_add_u32 s19, s16, 21504
  buffer_load_dwordx4 v13, s[60:63], s19 offen  lds
  s_waitcnt vmcnt(4)
  s_add_u32 m0, s17, 7168
  s_add_u32 s19, s16, 25088
  buffer_load_dwordx4 v13, s[60:63], s19 offen  lds
  s_cmp_eq_u32 s3, 3
  s_cbranch_scc1 L_wodone
  s_waitcnt vmcnt(4)
  s_mov_b64 exec, s[20:21]
  s_add_u32 m0, s17, 8192
  s_add_u32 s19, s16, 28672
  buffer_load_dwordx4 v12, s[60:63], s19 offen  lds
  s_waitcnt vmcnt(4)
  s_add_u32 m0, s17, 9216
  s_add_u32 s19, s16, 32256
  buffer_load_dwordx4 v12, s[60:63], s19 offen  lds
  s_waitcnt vmcnt(4)
  s_mov_b64 exec, s[22:23]
  s_add_u32 m0, s17, 10240
  s_add_u32 s19, s16, 35840
  buffer_load_dwordx4 v13, s[60:63], s19 offen  lds
  s_waitcnt vmcnt(4)
  s_add_u32 m0, s17, 11264
  s_add_u32 s19, s16, 39424
  buffer_load_dwordx4 v13, s[60:63], s19 offen  lds
  s_waitcnt vmcnt(4)
  s_mov_b64 exec, s[20:21]
  s_add_u32 m0, s17, 12288
  s_add_u32 s19, s16, 43008
  buffer_load_dwordx4 v12, s[60:63], s19 offen  lds
  s_waitcnt vmcnt(4)
  s_add_u32 m0, s17, 13312
  s_add_u32 s19, s16, 46592
  buffer_load_dwordx4 v12, s[60:63], s19 offen  lds
  s_waitcnt vmcnt(4)
  s_mov_b64 exec, s[22:23]
  s_add_u32 m0, s17, 14336
  s_add_u32 s19, s16, 50176
  buffer_load_dwordx4 v13, s[60:63], s19 offen  lds
  s_waitcnt vmcnt(4)
  s_add_u32 m0, s17, 15360
  s_add_u32 s19, s16, 53760
  buffer_load_dwordx4 v13, s[60:63], s19 offen  lds
  s_waitcnt vmcnt(4)
  s_mov_b64 exec, s[20:21]
  s_add_u32 m0, s17, 16384
  s_add_u32 s19, s16, 57344
  buffer_load_dwordx4 v12, s[60:63], s19 offen  lds
  s_waitcnt vmcnt(4)
  s_add_u32 m0, s17, 17408
  s_add_u32 s19, s16, 60928
  buffer_load_dwordx4 v12, s[60:63], s19 offen  lds
  s_waitcnt vmcnt(4)
  s_mov_b64 exec, s[22:23]
  s_add_u32 m0, s17, 18432
  s_add_u32 s19, s16, 64512
  buffer_load_dwordx4 v13, s[60:63], s19 offen  lds
  s_waitcnt vmcnt(4)
  s_add_u32 m0, s17, 19456
  s_add_u32 s19, s16, 68096
  buffer_load_dwordx4 v13, s[60:63], s19 offen  lds
  s_waitcnt vmcnt(4)
  s_mov_b64 exec, s[20:21]
  s_add_u32 m0, s17, 20480
  s_add_u32 s19, s16, 71680
  buffer_load_dwordx4 v12, s[60:63], s19 offen  lds
  s_waitcnt vmcnt(4)
  s_add_u32 m0, s17, 21504
  s_add_u32 s19, s16, 75264
  buffer_load_dwordx4 v12, s[60:63], s19 offen  lds
  s_waitcnt vmcnt(4)
  s_mov_b64 exec, s[22:23]
  s_add_u32 m0, s17, 22528
  s_add_u32 s19, s16, 78848
  buffer_load_dwordx4 v13, s[60:63], s19 offen  lds
  s_waitcnt vmcnt(4)
  s_add_u32 m0, s17, 23552
  s_add_u32 s19, s16, 82432
  buffer_load_dwordx4 v13, s[60:63], s19 offen  lds
  s_waitcnt vmcnt(4)
  s_mov_b64 exec, s[20:21]
  s_add_u32 m0, s17, 24576
  s_add_u32 s19, s16, 86016
  buffer_load_dwordx4 v12, s[60:63], s19 offen  lds
  s_waitcnt vmcnt(4)
  s_add_u32 m0, s17, 25600
  s_add_u32 s19, s16, 89600
  buffer_load_dwordx4 v12, s[60:63], s19 offen  lds
  s_waitcnt vmcnt(4)
  s_mov_b64 exec, s[22:23]
  s_add_u32 m0, s17, 26624
  s_add_u32 s19, s16, 93184
  buffer_load_dwordx4 v13, s[60:63], s19 offen  lds
  s_waitcnt vmcnt(4)
  s_add_u32 m0, s17, 27648
  s_add_u32 s19, s16, 96768
  buffer_load_dwordx4 v13, s[60:63], s19 offen  lds
  s_waitcnt vmcnt(4)
  s_mov_b64 exec, s[20:21]
  s_add_u32 m0, s17, 28672
  s_add_u32 s19, s16, 100352
  buffer_load_dwordx4 v12, s[60:63], s19 offen  lds
  s_waitcnt vmcnt(4)
  s_add_u32 m0, s17, 29696
  s_add_u32 s19, s16, 103936
  buffer_load_dwordx4 v12, s[60:63], s19 offen  lds
  s_waitcnt vmcnt(4)
  s_mov_b64 exec, s[22:23]
  s_add_u32 m0, s17, 30720
  s_add_u32 s19, s16, 107520
  buffer_load_dwordx4 v13, s[60:63], s19 offen  lds
  s_waitcnt vmcnt(4)
  s_add_u32 m0, s17, 31744
  s_add_u32 s19, s16, 111104
  buffer_load_dwordx4 v13, s[60:63], s19 offen  lds
  s_waitcnt vmcnt(4)
  s_mov_b64 exec, s[20:21]
  s_add_u32 m0, s17, 32768
  s_add_u32 s19, s16, 114688
  buffer_load_dwordx4 v12, s[60:63], s19 offen  lds
  s_waitcnt vmcnt(4)
  s_add_u32 m0, s17, 33792
  s_add_u32 s19, s16, 118272
  buffer_load_dwordx4 v12, s[60:63], s19 offen  lds
  s_waitcnt vmcnt(4)
  s_mov_b64 exec, s[22:23]
  s_add_u32 m0, s17, 34816
  s_add_u32 s19, s16, 121856
  buffer_load_dwordx4 v13, s[60:63], s19 offen  lds
  s_waitcnt vmcnt(4)
  s_add_u32 m0, s17, 35840
  s_add_u32 s19, s16, 125440
  buffer_load_dwordx4 v13, s[60:63], s19 offen  lds
  s_waitcnt vmcnt(4)
  s_mov_b64 exec, s[20:21]
  s_add_u32 m0, s17, 36864
  s_add_u32 s19, s16, 129024
  buffer_load_dwordx4 v12, s[60:63], s19 offen  lds
  s_waitcnt vmcnt(4)
  s_add_u32 m0, s17, 37888
  s_add_u32 s19, s16, 132608
  buffer_load_dwordx4 v12, s[60:63], s19 offen  lds
  s_waitcnt vmcnt(4)
  s_mov_b64 exec, s[22:23]
  s_add_u32 m0, s17, 38912
  s_add_u32 s19, s16, 136192
  buffer_load_dwordx4 v13, s[60:63], s19 offen  lds
  s_waitcnt vmcnt(4)
  s_add_u32 m0, s17, 39936
  s_add_u32 s19, s16, 139776
  buffer_load_dwordx4 v13, s[60:63], s19 offen  lds
L_wodone:
  s_mov_b64 exec, -1
  s_waitcnt vmcnt(0)
  s_cmp_lg_u32 s3, 3
  s_cbranch_scc1 L_nostat
  v_mov_b32 v12, 140440
  s_mov_b32 s15, 1048576
L_lw_136:
  ds_read_b32 v13, v12
  s_waitcnt lgkmcnt(0)
  v_cmp_gt_u32 vcc, 4, v13
  s_cbranch_vccz L_lwd_137
  s_sleep 4
  s_sub_u32 s15, s15, 1
  s_cmp_lg_u32 s15, 0
  s_cbranch_scc1 L_lw_136
L_lwd_137:
  v_lshrrev_b32 v12, 3, v0
  v_lshlrev_b32 v12, 2, v12
  v_and_b32 v13, 7, v0
  v_lshl_add_u32 v12, v13, 8, v12
  v_add_u32 v12, 146944, v12
  ds_read_b32 v40, v12 offset:0
  ds_read_b32 v41, v12 offset:64
  ds_read_b32 v42, v12 offset:128
  ds_read_b32 v43, v12 offset:192
  v_lshlrev_b32 v13, 4, v0
  s_lshl_b32 s19, s7, 11
  s_add_u32 s19, s19, 1310720
  s_waitcnt lgkmcnt(0)
  v_min_u32 v40, -2, v40
  v_min_u32 v41, -2, v41
  v_min_u32 v42, -2, v42
  v_min_u32 v43, -2, v43
  buffer_store_dwordx4 v[40:43], v13, s[88:91], s19 offen offset:0 sc1
  v_mov_b32 v12, 140416
  s_mov_b32 s15, 1048576
L_lw_138:
  ds_read_b32 v13, v12
  s_waitcnt lgkmcnt(0)
  v_cmp_gt_u32 vcc, 4, v13
  s_cbranch_vccz L_lwd_139
  s_sleep 4
  s_sub_u32 s15, s15, 1
  s_cmp_lg_u32 s15, 0
  s_cbranch_scc1 L_lw_138
L_lwd_139:
  v_and_b32 v14, 1, v0
  v_lshlrev_b32 v15, 3, v14
  v_add_u32 v12, 140288, v15
  ds_read_b64 v[16:17], v12 offset:0
  ds_read_b64 v[18:19], v12 offset:16
  ds_read_b64 v[20:21], v12 offset:32
  ds_read_b64 v[22:23], v12 offset:48
  s_waitcnt lgkmcnt(0)
  v_max_f32 v24, v16, v18
  v_max3_f32 v24, v20, v22, v24
  v_sub_f32 v28, v16, v24
  v_mul_f32 v28, s14, v28
  v_exp_f32 v28, v28
  v_sub_f32 v29, v18, v24
  v_mul_f32 v29, s14, v29
  v_exp_f32 v29, v29
  v_sub_f32 v30, v20, v24
  v_mul_f32 v30, s14, v30
  v_exp_f32 v30, v30
  v_sub_f32 v31, v22, v24
  v_mul_f32 v31, s14, v31
  v_exp_f32 v31, v31
  s_nop 0
  v_mul_f32 v25, v28, v17
  v_fma_f32 v25, v29, v19, v25
  v_fma_f32 v25, v30, v21, v25
  v_fma_f32 v25, v31, v23, v25
  v_min_u32 v24, -2, v24
  v_min_u32 v25, -2, v25
  s_lshl_b32 s19, s7, 7
  s_add_u32 s19, s19, 589824
  s_mov_b64 exec, 3
  buffer_store_dwordx2 v[24:25], v15, s[88:91], s19 offen sc1
  s_mov_b64 exec, -1
  s_xor_b32 s21, s19, 128
  s_xor_b32 s22, s19, 256
  s_xor_b32 s23, s19, 384
  s_mov_b32 s15, 1048576
L_p_140:
  buffer_load_dwordx2 v[32:33], v15, s[88:91], s21 offen sc1
  buffer_load_dwordx2 v[34:35], v15, s[88:91], s22 offen sc1
  buffer_load_dwordx2 v[36:37], v15, s[88:91], s23 offen sc1
  s_waitcnt vmcnt(0)
  v_max3_u32 v12, v32, v33, v34
  v_max3_u32 v12, v12, v35, v36
  v_max_u32 v12, v12, v37
  v_cmp_eq_u32 vcc, -1, v12
  s_cbranch_vccz L_pd_141
  s_sub_u32 s15, s15, 1
  s_cmp_lg_u32 s15, 0
  s_cbranch_scc1 L_p_140
L_pd_141:
  v_max_f32 v46, v24, v32
  v_max3_f32 v46, v34, v36, v46
  v_sub_f32 v48, v24, v46
  v_mul_f32 v48, s14, v48
  v_exp_f32 v48, v48
  v_sub_f32 v49, v32, v46
  v_mul_f32 v49, s14, v49
  v_exp_f32 v49, v49
  v_sub_f32 v50, v34, v46
  v_mul_f32 v50, s14, v50
  v_exp_f32 v50, v50
  v_sub_f32 v51, v36, v46
  v_mul_f32 v51, s14, v51
  v_exp_f32 v51, v51
  s_nop 0
  v_mul_f32 v47, v48, v25
  v_fma_f32 v47, v49, v33, v47
  v_fma_f32 v47, v50, v35, v47
  v_fma_f32 v47, v51, v37, v47
  v_rcp_f32 v52, v47
  s_nop 0
  v_fma_f32 v53, -v47, v52, 1.0
  v_fma_f32 v52, v53, v52, v52
  v_sub_f32 v28, v16, v46
  v_mul_f32 v28, s14, v28
  v_exp_f32 v28, v28
  v_sub_f32 v29, v18, v46
  v_mul_f32 v29, s14, v29
  v_exp_f32 v29, v29
  v_sub_f32 v30, v20, v46
  v_mul_f32 v30, s14, v30
  v_exp_f32 v30, v30
  v_sub_f32 v31, v22, v46
  v_mul_f32 v31, s14, v31
  v_exp_f32 v31, v31
  v_mul_f32 v53, s14, v46
  v_sub_f32 v53, 0, v53
  v_lshlrev_b32 v12, 2, v14
  v_add_u32 v12, 140352, v12
  ds_write_b32 v12, v28 offset:0
  ds_write_b32 v12, v29 offset:8
  ds_write_b32 v12, v30 offset:16
  ds_write_b32 v12, v31 offset:24
  ds_write_b32 v12, v53 offset:32
  ds_write_b32 v12, v52 offset:40
  v_mov_b32 v12, 140420
  v_mov_b32 v13, 1
  s_mov_b64 exec, 1
  ds_add_u32 v12, v13
  s_mov_b64 exec, -1
  s_waitcnt lgkmcnt(0)
L_nostat:
  v_cmp_gt_u32 vcc, 56, v0
  v_mov_b32 v11, 1.0
  v_lshlrev_b32 v70, 16, v64
  v_cndmask_b32 v11, 0, v11, vcc
  v_and_b32 v71, 0xffff0000, v64
  v_lshlrev_b32 v72, 16, v65
  v_and_b32 v73, 0xffff0000, v65
  v_lshlrev_b32 v74, 16, v66
  v_and_b32 v75, 0xffff0000, v66
  v_lshlrev_b32 v76, 16, v67
  v_and_b32 v77, 0xffff0000, v67
  v_lshlrev_b32 v78, 16, v68
  v_and_b32 v79, 0xffff0000, v68
L_tail:
  v_mov_b32 v12, 140420
  s_mov_b32 s15, 1048576
L_lw_142:
  ds_read_b32 v13, v12
  s_waitcnt lgkmcnt(0)
  v_cmp_gt_u32 vcc, 1, v13
  s_cbranch_vccz L_lwd_143
  s_sleep 8
  s_sub_u32 s15, s15, 1
  s_cmp_lg_u32 s15, 0
  s_cbranch_scc1 L_lw_142
L_lwd_143:
  s_lshr_b32 s16, s3, 1
  s_lshl_b32 s16, s16, 2
  s_add_u32 s16, s16, 140352
  v_mov_b32 v12, s16
  ds_read_b32 v64, v12 offset:40
  v_and_b32 v14, 31, v0
  v_lshlrev_b32 v14, 4, v14
  s_lshl_b32 s16, s3, 9
  v_lshrrev_b32 v13, 5, v0
  v_lshl_add_u32 v12, v13, 12, v14
  s_add_u32 s19, s16, 132096
  v_add_u32 v12, s19, v12
  s_lshl_b32 s19, s7, 11
  s_add_u32 s19, s19, 65536
  s_add_u32 s19, s19, s16
  s_and_b32 s17, s7, 3
  s_xor_b32 s20, s17, 1
  s_xor_b32 s21, s17, 2
  s_xor_b32 s22, s17, 3
  s_lshl_b32 s20, s20, 11
  s_lshl_b32 s21, s21, 11
  s_lshl_b32 s22, s22, 11
  v_cmp_eq_u32 vcc, 0, v13
  v_mov_b32 v16, s20
  v_mov_b32 v17, s21
  v_mov_b32 v18, s22
  v_cndmask_b32 v16, v18, v16, vcc
  v_add_u32 v65, v16, v14
  v_add_u32 v66, v17, v14
  s_andn2_b32 s17, s19, 0x1800
  v_lshrrev_b32 v15, 1, v14
  s_lshl_b32 s16, s3, 8
  s_add_u32 s16, s16, 140544
  v_add_u32 v15, s16, v15
  s_waitcnt lgkmcnt(0)
  s_barrier
  ds_read_b128 v[16:19], v12
  ds_read_b128 v[20:23], v12 offset:2048
  s_waitcnt lgkmcnt(0)
  v_add_f32 v16, v16, v20
  v_add_f32 v17, v17, v21
  v_add_f32 v18, v18, v22
  v_add_f32 v19, v19, v23
  v_mov_b32 v20, v16
  v_mov_b32 v21, v17
  v_mov_b32 v22, v18
  v_mov_b32 v23, v19
  s_nop 0
  v_permlane32_swap_b32 v16, v20
  v_permlane32_swap_b32 v17, v21
  v_permlane32_swap_b32 v18, v22
  v_permlane32_swap_b32 v19, v23
  s_nop 0
  v_add_f32 v24, v16, v20
  v_add_f32 v25, v17, v21
  v_add_f32 v26, v18, v22
  v_add_f32 v27, v19, v23
  v_min_u32 v24, -2, v24
  v_min_u32 v25, -2, v25
  v_min_u32 v26, -2, v26
  v_min_u32 v27, -2, v27
  s_mov_b32 exec_hi, 0
  buffer_store_dwordx4 v[24:27], v14, s[88:91], s19 offen sc1
  s_mov_b64 exec, -1
L_t3pre:
  v_lshrrev_b32 v4, 2, v2
  v_and_b32 v5, 1, v3
  v_lshl_or_b32 v5, v5, 2, v4
  v_xor_b32 v5, s3, v5
  v_lshlrev_b32 v5, 5, v5
  v_and_b32 v6, 3, v2
  v_lshl_add_u32 v5, v6, 3, v5
  v_lshl_add_u32 v4, v3, 3, v4
  v_lshl_add_u32 v5, v4, 8, v5
  v_add_u32 v6, 0x10000, v5
  ds_read_b64_tr_b16 v[80:81], v5 offset:0
  ds_read_b64_tr_b16 v[82:83], v5 offset:1024
  ds_read_b64_tr_b16 v[84:85], v5 offset:8192
  ds_read_b64_tr_b16 v[86:87], v5 offset:9216
  ds_read_b64_tr_b16 v[88:89], v5 offset:16384
  ds_read_b64_tr_b16 v[90:91], v5 offset:17408
  ds_read_b64_tr_b16 v[92:93], v5 offset:24576
  ds_read_b64_tr_b16 v[94:95], v5 offset:25600
  ds_read_b64_tr_b16 v[96:97], v5 offset:32768
  ds_read_b64_tr_b16 v[98:99], v5 offset:33792
  ds_read_b64_tr_b16 v[100:101], v5 offset:40960
  ds_read_b64_tr_b16 v[102:103], v5 offset:41984
  s_waitcnt lgkmcnt(2)
  ds_read_b64_tr_b16 v[104:105], v5 offset:49152
  ds_read_b64_tr_b16 v[106:107], v5 offset:50176
  ds_read_b64_tr_b16 v[108:109], v5 offset:57344
  ds_read_b64_tr_b16 v[110:111], v5 offset:58368
  ds_read_b64_tr_b16 v[112:113], v6 offset:0
  ds_read_b64_tr_b16 v[114:115], v6 offset:1024
  ds_read_b64_tr_b16 v[116:117], v6 offset:8192
  ds_read_b64_tr_b16 v[118:119], v6 offset:9216
  ds_read_b64_tr_b16 v[120:121], v6 offset:16384
  ds_read_b64_tr_b16 v[122:123], v6 offset:17408
  ds_read_b64_tr_b16 v[124:125], v6 offset:24576
  ds_read_b64_tr_b16 v[126:127], v6 offset:25600
  s_waitcnt lgkmcnt(2)
  ds_read_b64_tr_b16 v[128:129], v6 offset:32768
  ds_read_b64_tr_b16 v[130:131], v6 offset:33792
  ds_read_b64_tr_b16 v[132:133], v6 offset:40960
  ds_read_b64_tr_b16 v[134:135], v6 offset:41984
  ds_read_b64_tr_b16 v[136:137], v6 offset:49152
  ds_read_b64_tr_b16 v[138:139], v6 offset:50176
  ds_read_b64_tr_b16 v[140:141], v6 offset:57344
  ds_read_b64_tr_b16 v[142:143], v6 offset:58368
  v_lshlrev_b32 v7, 4, v3
  v_add_u32 v4, 140544, v7
  s_lshl_b32 s10, s7, 9
  s_add_u32 s10, s10, 655360
  v_lshl_add_u32 v9, v2, 17, v7
  s_lshl_b32 s11, s3, 6
  s_add_u32 s10, s10, s11
  s_mov_b32 s26, 0x00010001
  s_mov_b32 s27, 0x00010001
  s_cmp_ge_u32 s3, 4
  s_cbranch_scc1 L_t3
  v_mov_b32 v36, 0
  v_mov_b32 v37, 0
  v_mov_b32 v38, 0
  v_mov_b32 v39, 0
  s_waitcnt vmcnt(0)
  s_mov_b32 s15, 1048576
L_p_144:
  buffer_load_dwordx4 v[32:35], v65, s[88:91], s17 offen sc1
  s_mov_b32 exec_hi, 0
  buffer_load_dwordx4 v[36:39], v66, s[88:91], s17 offen sc1
  s_mov_b64 exec, -1
  s_waitcnt vmcnt(0)
  v_max3_u32 v12, v32, v33, v34
  v_max3_u32 v12, v12, v35, v36
  v_max3_u32 v12, v12, v37, v38
  v_max_u32 v12, v12, v39
  v_cmp_eq_u32 vcc, -1, v12
  s_cbranch_vccz L_pd_145
  s_sub_u32 s15, s15, 1
  s_cmp_lg_u32 s15, 0
  s_cbranch_scc1 L_p_144
L_pd_145:
  v_add_f32 v16, v32, v36
  v_add_f32 v17, v33, v37
  v_add_f32 v18, v34, v38
  v_add_f32 v19, v35, v39
  v_mov_b32 v20, v16
  v_mov_b32 v21, v17
  v_mov_b32 v22, v18
  v_mov_b32 v23, v19
  s_nop 0
  v_permlane32_swap_b32 v16, v20
  v_permlane32_swap_b32 v17, v21
  v_permlane32_swap_b32 v18, v22
  v_permlane32_swap_b32 v19, v23
  v_add_f32 v24, v24, v16
  v_add_f32 v25, v25, v17
  v_add_f32 v26, v26, v18
  v_add_f32 v27, v27, v19
  v_add_f32 v24, v24, v20
  v_add_f32 v25, v25, v21
  v_add_f32 v26, v26, v22
  v_add_f32 v27, v27, v23
  v_mul_f32 v24, v24, v64
  v_mul_f32 v25, v25, v64
  v_mul_f32 v26, v26, v64
  v_mul_f32 v27, v27, v64
  v_cvt_pk_bf16_f32 v24, v24, v25
  v_cvt_pk_bf16_f32 v25, v26, v27
  ds_write_b64 v15, v[24:25]
L_t3:
  s_waitcnt lgkmcnt(0)
  s_barrier
  ds_read_b128 v[32:35], v4 offset:0
  ds_read_b128 v[36:39], v4 offset:64
  ds_read_b128 v[40:43], v4 offset:128
  ds_read_b128 v[44:47], v4 offset:192
  ds_read_b128 v[48:51], v4 offset:256
  ds_read_b128 v[52:55], v4 offset:320
  ds_read_b128 v[56:59], v4 offset:384
  ds_read_b128 v[60:63], v4 offset:448
  s_waitcnt lgkmcnt(7)
  v_mfma_f32_16x16x32_bf16 v[16:19], v[80:83], v[32:35], 0
  ds_read_b128 v[32:35], v4 offset:512
  s_waitcnt lgkmcnt(7)
  v_mfma_f32_16x16x32_bf16 v[16:19], v[84:87], v[36:39], v[16:19]
  ds_read_b128 v[36:39], v4 offset:576
  s_waitcnt lgkmcnt(7)
  v_mfma_f32_16x16x32_bf16 v[16:19], v[88:91], v[40:43], v[16:19]
  ds_read_b128 v[40:43], v4 offset:640
  s_waitcnt lgkmcnt(7)
  v_mfma_f32_16x16x32_bf16 v[16:19], v[92:95], v[44:47], v[16:19]
  ds_read_b128 v[44:47], v4 offset:704
  s_waitcnt lgkmcnt(7)
  v_mfma_f32_16x16x32_bf16 v[16:19], v[96:99], v[48:51], v[16:19]
  ds_read_b128 v[48:51], v4 offset:768
  s_waitcnt lgkmcnt(7)
  v_mfma_f32_16x16x32_bf16 v[16:19], v[100:103], v[52:55], v[16:19]
  ds_read_b128 v[52:55], v4 offset:832
  s_waitcnt lgkmcnt(7)
  v_mfma_f32_16x16x32_bf16 v[16:19], v[104:107], v[56:59], v[16:19]
  ds_read_b128 v[56:59], v4 offset:896
  s_waitcnt lgkmcnt(7)
  v_mfma_f32_16x16x32_bf16 v[16:19], v[108:111], v[60:63], v[16:19]
  ds_read_b128 v[60:63], v4 offset:960
  s_waitcnt lgkmcnt(7)
  v_mfma_f32_16x16x32_bf16 v[16:19], v[112:115], v[32:35], v[16:19]
  s_waitcnt lgkmcnt(6)
  v_mfma_f32_16x16x32_bf16 v[16:19], v[116:119], v[36:39], v[16:19]
  s_waitcnt lgkmcnt(5)
  v_mfma_f32_16x16x32_bf16 v[16:19], v[120:123], v[40:43], v[16:19]
  s_waitcnt lgkmcnt(4)
  v_mfma_f32_16x16x32_bf16 v[16:19], v[124:127], v[44:47], v[16:19]
  s_waitcnt lgkmcnt(3)
  v_mfma_f32_16x16x32_bf16 v[16:19], v[128:131], v[48:51], v[16:19]
  s_waitcnt lgkmcnt(2)
  v_mfma_f32_16x16x32_bf16 v[16:19], v[132:135], v[52:55], v[16:19]
  s_waitcnt lgkmcnt(1)
  v_mfma_f32_16x16x32_bf16 v[16:19], v[136:139], v[56:59], v[16:19]
  s_waitcnt lgkmcnt(0)
  v_mfma_f32_16x16x32_bf16 v[16:19], v[140:143], v[60:63], v[16:19]
  s_mov_b32 exec_lo, 0x10001
  s_mov_b32 exec_hi, 0x10001
  s_nop 5
  v_min_u32 v16, -2, v16
  v_min_u32 v17, -2, v17
  v_min_u32 v18, -2, v18
  v_min_u32 v19, -2, v19
  buffer_store_dwordx4 v[16:19], v9, s[88:91], s10 offen sc1
  s_mov_b64 exec, -1
  s_cmp_ge_u32 s3, 4
  s_cbranch_scc1 L_send
  s_cmp_ge_u32 s13, 28
  s_cbranch_scc1 L_fin
  v_lshl_add_u32 v12, v13, 13, v14
  s_lshl_b32 s19, s5, 5
  s_add_u32 s19, s19, s3
  s_lshl_b32 s19, s19, 9
  s_add_u32 s19, s19, 655360
  s_add_u32 s17, s19, 4096
  v_lshrrev_b32 v15, 1, v14
  s_lshl_b32 s16, s3, 8
  s_add_u32 s16, s16, 141568
  v_add_u32 v15, s16, v15
  v_lshlrev_b32 v10, 4, v0
  s_lshl_b32 s16, s3, 10
  s_add_u32 s16, s16, 142592
  v_add_u32 v4, s16, v10
  v_add_u32 v10, 141568, v10
  v_add_u32 v6, 146688, v7
  v_add_u32 v5, s16, v7
  v_lshl_add_u32 v8, v2, 6, v7
  v_lshlrev_b32 v7, 3, v3
  s_lshl_b32 s16, s3, 5
  s_add_u32 s16, s16, 146688
  v_add_u32 v7, s16, v7
  v_mov_b32 v80, 0
  v_mov_b32 v81, 0
  v_mov_b32 v82, 0
  v_mov_b32 v83, 0
  v_mov_b32 v84, 0
  v_mov_b32 v85, 0
  v_mov_b32 v86, 0
  v_mov_b32 v87, 0
  v_mov_b32 v88, 0
  v_mov_b32 v89, 0
  v_mov_b32 v90, 0
  v_mov_b32 v91, 0
  v_mov_b32 v92, 0
  v_mov_b32 v93, 0
  v_mov_b32 v94, 0
  v_mov_b32 v95, 0
  v_mov_b32 v96, 0
  v_mov_b32 v97, 0
  v_mov_b32 v98, 0
  v_mov_b32 v99, 0
  v_mov_b32 v100, 0
  v_mov_b32 v101, 0
  v_mov_b32 v102, 0
  v_mov_b32 v103, 0
  v_mov_b32 v104, 0
  v_mov_b32 v105, 0
  v_mov_b32 v106, 0
  v_mov_b32 v107, 0
  v_mov_b32 v108, 0
  v_mov_b32 v109, 0
  v_mov_b32 v110, 0
  v_mov_b32 v111, 0
  v_mov_b32 v112, 0
  v_mov_b32 v113, 0
  v_mov_b32 v114, 0
  v_mov_b32 v115, 0
  v_mov_b32 v116, 0
  v_mov_b32 v117, 0
  v_mov_b32 v118, 0
  v_mov_b32 v119, 0
  v_mov_b32 v120, 0
  v_mov_b32 v121, 0
  v_mov_b32 v122, 0
  v_mov_b32 v123, 0
  v_mov_b32 v124, 0
  v_mov_b32 v125, 0
  v_mov_b32 v126, 0
  v_mov_b32 v127, 0
  v_mov_b32 v128, 0
  v_mov_b32 v129, 0
  v_mov_b32 v130, 0
  v_mov_b32 v131, 0
  v_mov_b32 v132, 0
  v_mov_b32 v133, 0
  v_mov_b32 v134, 0
  v_mov_b32 v135, 0
  s_waitcnt vmcnt(0)
  s_mov_b32 s15, 1048576
L_p_146:
  buffer_load_dwordx4 v[32:35], v12, s[88:91], s19 offen sc1
  buffer_load_dwordx4 v[36:39], v12, s[88:91], s19 offen offset:2048 sc1
  buffer_load_dwordx4 v[40:43], v12, s[88:91], s17 offen sc1
  buffer_load_dwordx4 v[44:47], v12, s[88:91], s17 offen offset:2048 sc1
  s_waitcnt vmcnt(0)
  v_max3_u32 v16, v32, v33, v34
  v_max3_u32 v16, v16, v35, v36
  v_max3_u32 v16, v16, v37, v38
  v_max3_u32 v16, v16, v39, v40
  v_max3_u32 v16, v16, v41, v42
  v_max3_u32 v16, v16, v43, v44
  v_max3_u32 v16, v16, v45, v46
  v_max_u32 v16, v16, v47
  v_cmp_eq_u32 vcc, -1, v16
  s_cbranch_vccz L_pd_147
  s_sub_u32 s15, s15, 1
  s_cmp_lg_u32 s15, 0
  s_cbranch_scc1 L_p_146
L_pd_147:
  v_add_f32 v16, v32, v36
  v_add_f32 v17, v33, v37
  v_add_f32 v18, v34, v38
  v_add_f32 v19, v35, v39
  v_add_f32 v20, v40, v44
  v_add_f32 v21, v41, v45
  v_add_f32 v22, v42, v46
  v_add_f32 v23, v43, v47
  v_add_f32 v16, v16, v20
  v_add_f32 v17, v17, v21
  v_add_f32 v18, v18, v22
  v_add_f32 v19, v19, v23
  v_mov_b32 v20, v16
  v_mov_b32 v21, v17
  v_mov_b32 v22, v18
  v_mov_b32 v23, v19
  s_nop 0
  v_permlane32_swap_b32 v16, v20
  v_permlane32_swap_b32 v17, v21
  v_permlane32_swap_b32 v18, v22
  v_permlane32_swap_b32 v19, v23
  s_nop 0
  v_add_f32 v16, v16, v20
  v_add_f32 v17, v17, v21
  v_add_f32 v18, v18, v22
  v_add_f32 v19, v19, v23
  v_cvt_pk_bf16_f32 v20, v16, v17
  v_cvt_pk_bf16_f32 v21, v18, v19
  v_lshlrev_b32 v16, 16, v20
  v_and_b32 v17, 0xffff0000, v20
  v_lshlrev_b32 v18, 16, v21
  v_and_b32 v19, 0xffff0000, v21
  v_add_f32 v16, v16, v70
  v_add_f32 v17, v17, v71
  v_add_f32 v18, v18, v72
  v_add_f32 v19, v19, v73
  v_cvt_pk_bf16_f32 v20, v16, v17
  v_cvt_pk_bf16_f32 v21, v18, v19
  ds_write_b64 v15, v[20:21]
  v_mov_b32 v16, 0
  v_mov_b32 v17, 0
  v_mov_b32 v18, 0
  v_mov_b32 v19, 0
  s_waitcnt lgkmcnt(0)
  s_barrier
  s_mov_b32 exec_hi, 0x00ffffff
  ds_read_b128 v[16:19], v10
  s_mov_b64 exec, -1
  s_waitcnt lgkmcnt(0)
  s_mov_b32 s10, 0x3b124925
  s_mov_b32 s11, 0xc3e00000
  v_lshlrev_b32 v20, 16, v16
  v_and_b32 v21, 0xffff0000, v16
  v_lshlrev_b32 v22, 16, v17
  v_and_b32 v23, 0xffff0000, v17
  v_lshlrev_b32 v24, 16, v18
  v_and_b32 v25, 0xffff0000, v18
  v_lshlrev_b32 v26, 16, v19
  v_and_b32 v27, 0xffff0000, v19
  v_add_f32 v32, v20, v21
  v_add_f32 v33, v22, v23
  v_add_f32 v34, v24, v25
  v_add_f32 v35, v26, v27
  v_add_f32 v36, v32, v33
  v_add_f32 v37, v34, v35
  v_add_f32 v28, v36, v37
  s_nop 1
  v_add_f32_dpp v28, v28, v28 quad_perm:[1,0,3,2] row_mask:0xf bank_mask:0xf
  s_nop 1
  v_add_f32_dpp v28, v28, v28 quad_perm:[2,3,0,1] row_mask:0xf bank_mask:0xf
  s_nop 1
  v_add_f32_dpp v28, v28, v28 row_half_mirror row_mask:0xf bank_mask:0xf
  s_nop 1
  v_add_f32_dpp v28, v28, v28 row_mirror row_mask:0xf bank_mask:0xf
  v_mov_b32 v29, v28
  s_nop 1
  v_permlane16_swap_b32 v28, v29
  s_nop 1
  v_add_f32 v28, v28, v29
  v_mov_b32 v29, v28
  s_nop 1
  v_permlane32_swap_b32 v28, v29
  s_nop 1
  v_add_f32 v28, v28, v29
  v_mul_f32 v29, 0x3b124925, v28
  v_fma_f32 v28, v29, s11, v28
  v_fma_f32 v28, v28, s10, v29
  v_sub_f32 v32, v20, v28
  v_sub_f32 v33, v21, v28
  v_sub_f32 v34, v22, v28
  v_sub_f32 v35, v23, v28
  v_sub_f32 v36, v24, v28
  v_sub_f32 v37, v25, v28
  v_sub_f32 v38, v26, v28
  v_sub_f32 v39, v27, v28
  v_mul_f32 v32, v32, v32
  v_mul_f32 v33, v33, v33
  v_mul_f32 v34, v34, v34
  v_mul_f32 v35, v35, v35
  v_fma_f32 v32, v36, v36, v32
  v_fma_f32 v33, v37, v37, v33
  v_fma_f32 v34, v38, v38, v34
  v_fma_f32 v35, v39, v39, v35
  v_add_f32 v36, v32, v33
  v_add_f32 v37, v34, v35
  v_add_f32 v30, v36, v37
  v_cvt_pk_bf16_f32 v28, v28, v28
  v_mul_f32 v30, v30, v11
  v_and_b32 v28, 0xffff0000, v28
  v_sub_f32 v20, v20, v28
  v_sub_f32 v21, v21, v28
  v_add_f32_dpp v30, v30, v30 quad_perm:[1,0,3,2] row_mask:0xf bank_mask:0xf
  v_sub_f32 v22, v22, v28
  v_sub_f32 v23, v23, v28
  v_add_f32_dpp v30, v30, v30 quad_perm:[2,3,0,1] row_mask:0xf bank_mask:0xf
  v_sub_f32 v24, v24, v28
  v_sub_f32 v25, v25, v28
  v_add_f32_dpp v30, v30, v30 row_half_mirror row_mask:0xf bank_mask:0xf
  v_sub_f32 v26, v26, v28
  v_sub_f32 v27, v27, v28
  v_add_f32_dpp v30, v30, v30 row_mirror row_mask:0xf bank_mask:0xf
  v_mov_b32 v29, v30
  v_cvt_pk_bf16_f32 v16, v20, v21
  v_cvt_pk_bf16_f32 v17, v22, v23
  v_permlane16_swap_b32 v30, v29
  v_cvt_pk_bf16_f32 v18, v24, v25
  v_cvt_pk_bf16_f32 v19, v26, v27
  v_add_f32 v30, v30, v29
  v_mov_b32 v29, v30
  v_lshlrev_b32 v20, 16, v16
  v_and_b32 v21, 0xffff0000, v16
  v_permlane32_swap_b32 v30, v29
  v_lshlrev_b32 v22, 16, v17
  v_and_b32 v23, 0xffff0000, v17
  v_add_f32 v30, v30, v29
  v_mul_f32 v29, 0x3b124925, v30
  v_fma_f32 v30, v29, s11, v30
  v_fma_f32 v30, v30, s10, v29
  v_cvt_pk_bf16_f32 v30, v30, v30
  v_and_b32 v30, 0xffff0000, v30
  v_add_f32 v30, 0x3727c5ac, v30
  v_cvt_pk_bf16_f32 v30, v30, v30
  v_and_b32 v30, 0xffff0000, v30
  v_sqrt_f32 v30, v30
  v_lshlrev_b32 v24, 16, v18
  v_cvt_pk_bf16_f32 v30, v30, v30
  v_and_b32 v30, 0xffff0000, v30
  v_rcp_f32 v30, v30
  v_and_b32 v25, 0xffff0000, v18
  v_lshlrev_b32 v26, 16, v19
  v_and_b32 v27, 0xffff0000, v19
  s_nop 0
  v_mul_f32 v20, v20, v30
  v_mul_f32 v21, v21, v30
  v_mul_f32 v22, v22, v30
  v_mul_f32 v23, v23, v30
  v_mul_f32 v24, v24, v30
  v_mul_f32 v25, v25, v30
  v_mul_f32 v26, v26, v30
  v_mul_f32 v27, v27, v30
  v_cvt_pk_bf16_f32 v16, v20, v21
  v_cvt_pk_bf16_f32 v17, v22, v23
  v_cvt_pk_bf16_f32 v18, v24, v25
  v_cvt_pk_bf16_f32 v19, v26, v27
  ds_write_b128 v4, v[16:19]
  s_waitcnt lgkmcnt(0)
  ds_read_b128 v[32:35], v5 offset:0
  ds_read_b128 v[36:39], v5 offset:64
  ds_read_b128 v[40:43], v5 offset:128
  ds_read_b128 v[44:47], v5 offset:192
  ds_read_b128 v[48:51], v5 offset:256
  ds_read_b128 v[52:55], v5 offset:320
  ds_read_b128 v[56:59], v5 offset:384
  ds_read_b128 v[60:63], v5 offset:448
  s_waitcnt lgkmcnt(7)
  v_mfma_f32_16x16x32_bf16 v[16:19], v[144:147], v[32:35], 0
  ds_read_b128 v[32:35], v5 offset:512
  s_waitcnt lgkmcnt(7)
  v_mfma_f32_16x16x32_bf16 v[16:19], v[148:151], v[36:39], v[16:19]
  ds_read_b128 v[36:39], v5 offset:576
  s_waitcnt lgkmcnt(7)
  v_mfma_f32_16x16x32_bf16 v[16:19], v[152:155], v[40:43], v[16:19]
  ds_read_b128 v[40:43], v5 offset:640
  s_waitcnt lgkmcnt(7)
  v_mfma_f32_16x16x32_bf16 v[16:19], v[156:159], v[44:47], v[16:19]
  ds_read_b128 v[44:47], v5 offset:704
  s_waitcnt lgkmcnt(7)
  v_mfma_f32_16x16x32_bf16 v[16:19], v[160:163], v[48:51], v[16:19]
  ds_read_b128 v[48:51], v5 offset:768
  s_waitcnt lgkmcnt(7)
  v_mfma_f32_16x16x32_bf16 v[16:19], v[164:167], v[52:55], v[16:19]
  ds_read_b128 v[52:55], v5 offset:832
  s_waitcnt lgkmcnt(7)
  v_mfma_f32_16x16x32_bf16 v[16:19], v[168:171], v[56:59], v[16:19]
  s_waitcnt lgkmcnt(6)
  v_mfma_f32_16x16x32_bf16 v[16:19], v[172:175], v[60:63], v[16:19]
  s_waitcnt lgkmcnt(5)
  v_mfma_f32_16x16x32_bf16 v[16:19], v[176:179], v[32:35], v[16:19]
  s_waitcnt lgkmcnt(4)
  v_mfma_f32_16x16x32_bf16 v[16:19], v[180:183], v[36:39], v[16:19]
  s_waitcnt lgkmcnt(3)
  v_mfma_f32_16x16x32_bf16 v[16:19], v[184:187], v[40:43], v[16:19]
  s_waitcnt lgkmcnt(2)
  v_mfma_f32_16x16x32_bf16 v[16:19], v[188:191], v[44:47], v[16:19]
  s_waitcnt lgkmcnt(1)
  v_mfma_f32_16x16x32_bf16 v[16:19], v[192:195], v[48:51], v[16:19]
  s_waitcnt lgkmcnt(0)
  v_mfma_f32_16x16x32_bf16 v[16:19], v[196:199], v[52:55], v[16:19]
  s_lshl_b32 s19, s5, 5
  s_add_u32 s19, s19, s13
  s_lshl_b32 s19, s19, 11
  s_add_u32 s19, s19, 786432
  s_mul_i32 s16, s3, 448
  s_add_u32 s19, s19, s16
  s_mov_b32 s24, 0x007f007f
  s_mov_b32 s25, 0x007f007f
  v_cvt_pk_bf16_f32 v20, v16, v17
  v_cvt_pk_bf16_f32 v21, v18, v19
  v_lshlrev_b32 v16, 16, v20
  v_and_b32 v17, 0xffff0000, v20
  v_lshlrev_b32 v18, 16, v21
  v_and_b32 v19, 0xffff0000, v21
  v_add_f32 v16, v16, v74
  v_add_f32 v17, v17, v75
  v_add_f32 v18, v18, v76
  v_add_f32 v19, v19, v77
  v_cvt_pk_bf16_f32 v20, v16, v17
  v_cvt_pk_bf16_f32 v21, v18, v19
  v_lshlrev_b32 v16, 16, v20
  v_and_b32 v17, 0xffff0000, v20
  v_lshlrev_b32 v18, 16, v21
  v_and_b32 v19, 0xffff0000, v21
  v_max_f32 v16, 0, v16
  v_max_f32 v17, 0, v17
  v_max_f32 v18, 0, v18
  v_max_f32 v19, 0, v19
  v_mul_f32 v16, v16, v16
  v_mul_f32 v17, v17, v17
  v_mul_f32 v18, v18, v18
  v_mul_f32 v19, v19, v19
  v_cvt_pk_bf16_f32 v20, v16, v17
  v_cvt_pk_bf16_f32 v21, v18, v19
  ds_write_b64 v7, v[20:21]
  s_waitcnt lgkmcnt(0)
  s_barrier
  s_lshl_b64 exec, s[26:27], 0
  ds_read_b128 v[80:83], v6 offset:0
  ds_read_b128 v[84:87], v6 offset:64
  s_lshl_b64 exec, s[26:27], 1
  ds_read_b128 v[88:91], v6 offset:0
  ds_read_b128 v[92:95], v6 offset:64
  s_lshl_b64 exec, s[26:27], 2
  ds_read_b128 v[96:99], v6 offset:0
  ds_read_b128 v[100:103], v6 offset:64
  s_lshl_b64 exec, s[26:27], 3
  ds_read_b128 v[104:107], v6 offset:0
  ds_read_b128 v[108:111], v6 offset:64
  s_lshl_b64 exec, s[26:27], 4
  ds_read_b128 v[112:115], v6 offset:0
  ds_read_b128 v[116:119], v6 offset:64
  s_lshl_b64 exec, s[26:27], 5
  ds_read_b128 v[120:123], v6 offset:0
  ds_read_b128 v[124:127], v6 offset:64
  s_lshl_b64 exec, s[26:27], 6
  ds_read_b128 v[128:131], v6 offset:0
  ds_read_b128 v[132:135], v6 offset:64
  s_mov_b64 exec, -1
  s_waitcnt lgkmcnt(13)
  v_mfma_f32_16x16x32_bf16 v[16:19], v[200:203], v[80:83], 0
  s_waitcnt lgkmcnt(12)
  v_mfma_f32_16x16x32_bf16 v[16:19], v[204:207], v[84:87], v[16:19]
  s_waitcnt lgkmcnt(11)
  v_mfma_f32_16x16x32_bf16 v[16:19], v[208:211], v[88:91], v[16:19]
  s_waitcnt lgkmcnt(10)
  v_mfma_f32_16x16x32_bf16 v[16:19], v[212:215], v[92:95], v[16:19]
  s_waitcnt lgkmcnt(9)
  v_mfma_f32_16x16x32_bf16 v[16:19], v[216:219], v[96:99], v[16:19]
  s_waitcnt lgkmcnt(8)
  v_mfma_f32_16x16x32_bf16 v[16:19], v[220:223], v[100:103], v[16:19]
  s_waitcnt lgkmcnt(7)
  v_mfma_f32_16x16x32_bf16 v[16:19], v[224:227], v[104:107], v[16:19]
  s_waitcnt lgkmcnt(6)
  v_mfma_f32_16x16x32_bf16 v[16:19], v[228:231], v[108:111], v[16:19]
  s_waitcnt lgkmcnt(5)
  v_mfma_f32_16x16x32_bf16 v[16:19], v[232:235], v[112:115], v[16:19]
  s_waitcnt lgkmcnt(4)
  v_mfma_f32_16x16x32_bf16 v[16:19], v[236:239], v[116:119], v[16:19]
  s_waitcnt lgkmcnt(3)
  v_mfma_f32_16x16x32_bf16 v[16:19], v[240:243], v[120:123], v[16:19]
  s_waitcnt lgkmcnt(2)
  v_mfma_f32_16x16x32_bf16 v[16:19], v[244:247], v[124:127], v[16:19]
  s_waitcnt lgkmcnt(1)
  v_mfma_f32_16x16x32_bf16 v[16:19], v[248:251], v[128:131], v[16:19]
  s_waitcnt lgkmcnt(0)
  v_mfma_f32_16x16x32_bf16 v[16:19], v[252:255], v[132:135], v[16:19]
  s_mov_b64 exec, s[24:25]
  s_nop 6
  v_min_u32 v16, -2, v16
  v_min_u32 v17, -2, v17
  v_min_u32 v18, -2, v18
  v_min_u32 v19, -2, v19
  buffer_store_dwordx4 v[16:19], v8, s[88:91], s19 offen sc1
  s_mov_b64 exec, -1
  s_cmp_lg_u32 s3, 0
  s_cbranch_scc1 L_fin
  v_lshrrev_b32 v12, 3, v0
  v_lshlrev_b32 v12, 11, v12
  v_and_b32 v13, 7, v0
  v_lshl_add_u32 v12, v13, 3, v12
  s_lshl_b32 s19, s5, 16
  s_add_u32 s19, s19, 786432
  s_lshl_b32 s16, s13, 6
  s_add_u32 s19, s19, s16
  s_add_u32 s20, s19, 0
  s_add_u32 s21, s19, 16384
  s_add_u32 s22, s19, 32768
  s_add_u32 s23, s19, 49152
  v_mov_b32 v38, 0
  v_mov_b32 v39, 0
  v_lshlrev_b32 v13, 2, v13
  s_lshl_b32 s16, s13, 5
  s_add_u32 s17, s16, 141568
  v_add_u32 v14, s17, v13
  ds_read_b32 v28, v14
  s_mul_i32 s19, s5, 896
  s_add_u32 s19, s19, s16
  s_waitcnt lgkmcnt(0)
  v_lshlrev_b32 v29, 16, v28
  v_and_b32 v28, 0xffff0000, v28
  s_waitcnt vmcnt(0)
  s_mov_b32 s15, 1048576
L_p_148:
  buffer_load_dwordx2 v[32:33], v12, s[88:91], s20 offen sc1
  buffer_load_dwordx2 v[34:35], v12, s[88:91], s21 offen sc1
  buffer_load_dwordx2 v[36:37], v12, s[88:91], s22 offen sc1
  s_mov_b32 exec_hi, 0
  buffer_load_dwordx2 v[38:39], v12, s[88:91], s23 offen sc1
  s_mov_b64 exec, -1
  s_waitcnt vmcnt(0)
  v_max3_u32 v15, v32, v33, v34
  v_max3_u32 v15, v15, v35, v36
  v_max3_u32 v15, v15, v37, v38
  v_max_u32 v15, v15, v39
  v_cmp_eq_u32 vcc, -1, v15
  s_cbranch_vccz L_pd_149
  s_sub_u32 s15, s15, 1
  s_cmp_lg_u32 s15, 0
  s_cbranch_scc1 L_p_148
L_pd_149:
  v_add_f32 v16, v32, v34
  v_add_f32 v18, v33, v35
  v_add_f32 v17, v36, v38
  v_add_f32 v19, v37, v39
  v_add_f32 v16, v16, v17
  v_add_f32 v18, v18, v19
  s_nop 0
  v_add_f32_dpp v16, v16, v16 row_ror:8 row_mask:0xf bank_mask:0xf
  v_add_f32_dpp v18, v18, v18 row_ror:8 row_mask:0xf bank_mask:0xf
  v_mov_b32 v17, v16
  v_mov_b32 v19, v18
  s_nop 1
  v_permlane16_swap_b32 v16, v17
  v_permlane16_swap_b32 v18, v19
  s_nop 1
  v_add_f32 v16, v16, v17
  v_add_f32 v18, v18, v19
  v_mov_b32 v17, v16
  v_mov_b32 v19, v18
  s_nop 1
  v_permlane32_swap_b32 v16, v17
  v_permlane32_swap_b32 v18, v19
  s_nop 1
  v_add_f32 v16, v16, v17
  v_add_f32 v18, v18, v19
  v_cvt_pk_bf16_f32 v16, v16, v18
  v_lshlrev_b32 v17, 16, v16
  v_and_b32 v16, 0xffff0000, v16
  v_add_f32 v17, v17, v78
  v_add_f32 v16, v16, v79
  v_cvt_pk_bf16_f32 v16, v17, v16
  v_lshlrev_b32 v17, 16, v16
  v_and_b32 v16, 0xffff0000, v16
  v_add_f32 v17, v17, v29
  v_add_f32 v16, v16, v28
  v_cvt_pk_bf16_f32 v16, v17, v16
  s_mov_b64 exec, 0xff
  buffer_store_dword v16, v13, s[80:83], s19 offen
  s_mov_b64 exec, -1
L_fin:
L_send:
L_end:
  s_endpgm
.section .rodata,"a"
.p2align 6
.amdhsa_kernel sequential_preLN__gqa_block_cached__dense_activation_squared_relu__decode_kernel
  .amdhsa_next_free_vgpr 256
  .amdhsa_next_free_sgpr 102
  .amdhsa_accum_offset 256
  .amdhsa_group_segment_fixed_size 0
  .amdhsa_kernarg_size 104
  .amdhsa_user_sgpr_count 2
  .amdhsa_user_sgpr_kernarg_segment_ptr 1
  .amdhsa_system_sgpr_workgroup_id_x 1
  .amdhsa_float_denorm_mode_32 3
.end_amdhsa_kernel
```
